```python
import torch

def _softmax(x, axis=-1):
    return torch.softmax(x, dim=axis)
def _gelu(x):
    return torch.nn.functional.gelu(x, approximate="tanh")
def _silu(x):
    return torch.nn.functional.silu(x)
def _sigmoid(x):
    return torch.sigmoid(x)
def _layernorm(x, axis=-1, eps=1e-5):
    m = x.mean(dim=axis, keepdim=True)
    v = x.var(dim=axis, keepdim=True, unbiased=False)
    return (x - m) / torch.sqrt(v + eps)
def _scatter_add(tgt, idx, src, axis=0):
    return tgt.clone().index_add_(axis, idx, src)
def _segment_sum(src, seg, n):
    out = torch.zeros((n,) + src.shape[1:], dtype=src.dtype)
    return out.index_add_(0, seg, src)
def _pad(x, pw):
    flat = tuple(v for pair in reversed(pw) for v in pair)
    return torch.nn.functional.pad(x, flat)

kernel_name = 'gated_mix__linear_kernel_hedgehog__ssm_conv_s5__prompt'

def setup_inputs():

    _w = (lambda a: (lambda t: t.to(torch.bfloat16) if t.is_floating_point() else t)(torch.as_tensor(a)))
    def _A_setup():
        B, S, D, H = 1, 2048, 512, 32
        Dh = D // H
        return {
            "x": _w((lambda *s: torch.randn(*s, dtype=torch.bfloat16) * 0.05)(B, S, D)),
            "wqkv": _w((lambda *s: torch.randn(*s, dtype=torch.bfloat16) * 1.6)(D, 3 * D)),
            "w_phi": _w((lambda *s: torch.randn(*s, dtype=torch.bfloat16) * 1.6)(H, Dh, Dh) * (Dh ** -0.5)),
            "wo": _w((lambda *s: torch.randn(*s, dtype=torch.bfloat16) * 0.05)(D, D)),
        }
    _A_in = _A_setup()

    def _B_setup():
        B, S, D = 1, 2048, 512
        P = D
        Lambda_re = -0.5 * (lambda _x: torch.exp(torch.as_tensor(_x)))((lambda *s: torch.randn(*s, dtype=torch.bfloat16) * 0.8)(P))
        Lambda_im = (lambda *s: torch.randn(*s, dtype=torch.bfloat16) * 0.8)(P) * 1.0
        B_re = (lambda *s: torch.randn(*s, dtype=torch.bfloat16) * 0.8)(P, D) * (D ** -0.5)
        B_im = (lambda *s: torch.randn(*s, dtype=torch.bfloat16) * 0.8)(P, D) * (D ** -0.5)
        C_re = (lambda *s: torch.randn(*s, dtype=torch.bfloat16) * 0.8)(D, P) * (P ** -0.5)
        C_im = (lambda *s: torch.randn(*s, dtype=torch.bfloat16) * 0.8)(D, P) * (P ** -0.5)
        log_dt = (lambda *s: torch.randn(*s, dtype=torch.bfloat16) * 0.8)(P) * 0.3 - 2.0
        Dskip = (lambda *s: torch.randn(*s, dtype=torch.bfloat16) * 0.8)(D)
        return {
            "x": _w((lambda *s: torch.randn(*s, dtype=torch.bfloat16) * 0.05)(B, S, D)),
            "Lambda_re": _w(Lambda_re),
            "Lambda_im": _w(Lambda_im),
            "B_re": _w(B_re),
            "B_im": _w(B_im),
            "C_re": _w(C_re),
            "C_im": _w(C_im),
            "log_dt": _w(log_dt),
            "Dskip": _w(Dskip),
        }
    _B_in = _B_setup()

    return {
        "A_x": _A_in["x"],
        "A_wqkv": _A_in["wqkv"],
        "A_w_phi": _A_in["w_phi"],
        "A_wo": _A_in["wo"],
        "B_x": _B_in["x"],
        "B_Lambda_re": _B_in["Lambda_re"],
        "B_Lambda_im": _B_in["Lambda_im"],
        "B_B_re": _B_in["B_re"],
        "B_B_im": _B_in["B_im"],
        "B_C_re": _B_in["C_re"],
        "B_C_im": _B_in["C_im"],
        "B_log_dt": _B_in["log_dt"],
        "B_Dskip": _B_in["Dskip"],
        "gate_w": _w((lambda *s: torch.randn(*s, dtype=torch.bfloat16) * 0.05)(512) * 16.0),
    }

def reference(A_x, A_wqkv, A_w_phi, A_wo, B_x, B_Lambda_re, B_Lambda_im, B_B_re, B_B_im, B_C_re, B_C_im, B_log_dt, B_Dskip, gate_w):
    def _A_ref(x, wqkv, w_phi, wo):
        B, S, D = x.shape
        H = 32; Dh = D // H
        qkv = (lambda x, *d: x.permute(*d))((x @ wqkv).reshape(B, S, 3, H, Dh), 2, 0, 3, 1, 4)
        q, k, v = qkv[0], qkv[1], qkv[2]
        pq = torch.einsum("bhsd,hdf->bhsf", q, w_phi)
        pk = torch.einsum("bhsd,hdf->bhsf", k, w_phi)
        phi_q = torch.concatenate([_softmax(pq, axis=-1), _softmax(-pq, axis=-1)], axis=-1)
        phi_k = torch.concatenate([_softmax(pk, axis=-1), _softmax(-pk, axis=-1)], axis=-1)
        kv = torch.einsum("bhsf,bhsd->bhfd", phi_k, v)
        z  = torch.einsum("bhsf->bhf", phi_k)
        num = torch.einsum("bhqf,bhfd->bhqd", phi_q, kv)
        den = torch.einsum("bhqf,bhf->bhq", phi_q, z)[..., None] + 1e-6
        o = num / den
        return (lambda x, *d: x.permute(*d))(o, 0, 2, 1, 3).reshape(B, S, D) @ wo

    def _B_ref(x, Lambda_re, Lambda_im, B_re, B_im, C_re, C_im, log_dt, Dskip):
        Bsz, L, H = x.shape
        Lam = Lambda_re + 1j * Lambda_im
        Bmat = B_re + 1j * B_im
        Cmat = C_re + 1j * C_im
        dt = torch.exp(log_dt)
        Lam_bar = torch.exp(dt * Lam)
        B_bar = ((Lam_bar - 1.0) / Lam)[:, None] * Bmat
        Bu = torch.einsum("bld,pd->blp", x + 0j, B_bar)
        h = torch.zeros_like(Bu[:, 0, :])
        hs = []
        for t in range(L):
            h = Lam_bar[None, :] * h + Bu[:, t, :]
            hs.append(h)
        hseq = torch.stack(hs, 1)
        y = 2.0 * torch.einsum("blp,dp->bld", hseq, Cmat).real + x * Dskip[None, None, :]
        return y

    x = A_x
    g = _sigmoid((x * gate_w).sum(-1, keepdims=True))
    a = _A_ref(x, A_wqkv, A_w_phi, A_wo)
    b = _B_ref(x, B_Lambda_re, B_Lambda_im, B_B_re, B_B_im, B_C_re, B_C_im, B_log_dt, B_Dskip)
    return g * a + (1 - g) * b
```

```asm
; @launch grid=(256,1,1) block=(256,1,1) lds=163840
.amdgcn_target "amdgcn-amd-amdhsa--gfx950"
.text
.globl gated_mix__linear_kernel_hedgehog__ssm_conv_s5__prompt_kernel
.p2align 8
.type gated_mix__linear_kernel_hedgehog__ssm_conv_s5__prompt_kernel,@function
gated_mix__linear_kernel_hedgehog__ssm_conv_s5__prompt_kernel:
    s_cmp_ge_u32 s2, 256
    s_cbranch_scc1 gm_END
    s_load_dwordx16 s[4:19], s[0:1], 0
    s_load_dwordx16 s[20:35], s[0:1], 64
    s_load_dwordx2 s[36:37], s[0:1], 128
    v_lshrrev_b32 v1, 6, v0
    v_and_b32 v0, 63, v0
    v_readfirstlane_b32 s80, v1
    s_and_b32 s86, s2, 7
    s_lshr_b32 s87, s2, 3
    s_and_b32 s88, s87, 7
    s_lshr_b32 s89, s87, 3
    s_and_b32 s81, s86, 1
    s_lshl_b32 s81, s81, 3
    s_add_u32 s81, s81, s88
    s_and_b32 s82, s86, 6
    s_and_b32 s38, s89, 1
    s_add_u32 s82, s82, s38
    s_lshr_b32 s93, s89, 1
    s_lshl_b32 s94, s88, 6
    s_lshl_b32 s95, s86, 8
    s_lshl_b32 s38, s89, 6
    s_add_u32 s95, s95, s38
    s_mov_b32 s96, 1069066811
    s_mov_b32 s97, 1069066811
    s_mov_b32 s92, 0
    v_and_b32 v5, 31, v0
    v_lshrrev_b32 v6, 5, v0
    v_lshrrev_b32 v7, 4, v0
    v_and_b32 v8, 15, v0
    s_add_u32 s38, s88, s89
    s_lshl_b32 s38, s38, 2
    s_mov_b32 s76, 811796016
    s_mov_b32 s77, 103834374
    s_lshr_b64 s[76:77], s[76:77], s38
    s_and_b32 s83, s76, 7
    s_xor_b32 s39, s88, s89
    s_and_b32 s88, s39, 1
    v_lshrrev_b32 v1, 3, v0
    v_and_b32 v2, 7, v0
    v_xor_b32 v3, v2, v7
    v_lshlrev_b32 v3, 4, v3
    v_lshl_add_u32 v3, v1, 10, v3
    s_lshl_b32 s38, s80, 15
    v_add_u32 v9, s38, v3
    v_xor_b32 v4, 64, v9
    v_add_u32 v10, 7168, v4
    v_add_u32 v11, 14336, v9
    v_add_u32 v12, 21504, v4
    v_xor_b32 v13, 64, v3
    v_and_b32 v4, 1, v7
    v_lshlrev_b32 v4, 2, v4
    v_xor_b32 v2, v2, v4
    v_lshlrev_b32 v2, 4, v2
    s_lshl_b32 s38, s80, 4
    v_add_u32 v16, s38, v1
    v_mul_u32_u24 v16, 3072, v16
    v_add_u32 v16, v16, v2
    v_add_u32 v17, 23552, v16
    s_lshl_b32 s38, s80, 14
    v_add_u32 v14, s38, v3
    s_add_u32 s38, s38, 7168
    v_add_u32 v15, s38, v13
    s_lshl_b32 s38, s82, 7
    s_add_u32 s38, s38, 1024
    s_lshl_b32 s39, s82, 16
    s_mov_b32 s3, 196608
    s_mov_b32 s50, 1572864
    s_cmp_lg_u32 s93, 0
    s_cselect_b64 s[98:99], -1, 0
    s_cselect_b32 s91, s39, s38
    s_cselect_b32 s3, 128, s3
    s_cselect_b32 s50, 524288, s50
    s_mov_b32 s54, s50
    v_cndmask_b32 v14, v16, v14, s[98:99]
    v_cndmask_b32 v15, v17, v15, s[98:99]
    v_lshlrev_b32 v18, 4, v0
    s_lshl_b32 s90, s81, 17
    s_mov_b32 s85, s83
    s_lshl_b32 s38, s85, 7
    s_add_u32 s86, s90, s38
    s_lshl_b32 m0, s80, 12
    s_mov_b32 s42, 2097152
    s_mov_b32 s43, 0x20000
    s_mul_i32 s87, s85, s3
    s_add_u32 s87, s87, s91
    s_mov_b32 s51, 0x20000
    s_mov_b32 s55, 0x20000
    v_and_b32 v17, 0x13, v5
    v_bfe_u32 v16, v5, 2, 1
    v_lshl_or_b32 v17, v16, 3, v17
    v_bfe_u32 v16, v5, 3, 1
    v_lshl_or_b32 v17, v16, 2, v17
    s_lshl_b32 s38, s82, 7
    s_cmp_lg_u32 s93, 0
    s_cselect_b32 s38, s38, 0x10000
    v_lshl_add_u32 v17, v17, 1, s38
    s_mov_b32 s78, 1024
    s_mov_b32 s79, 0x20000
    s_waitcnt lgkmcnt(0)
    s_mov_b32 s40, s4
    s_and_b32 s41, s5, 0xffff
    buffer_load_dwordx4 v9, s[40:43], s86 offen offset:0 lds
    buffer_load_dwordx4 v10, s[40:43], s86 offen offset:1024 lds
    buffer_load_dwordx4 v11, s[40:43], s86 offen offset:2048 lds
    buffer_load_dwordx4 v12, s[40:43], s86 offen offset:3072 lds
    s_mov_b32 s76, s14
    s_and_b32 s77, s15, 0xffff
    buffer_load_ushort v4, v17, s[76:79], 0 offen offset:0
    buffer_load_ushort v20, v17, s[76:79], 0 offen offset:64
    s_mov_b32 s76, s16
    s_and_b32 s77, s17, 0xffff
    buffer_load_ushort v16, v17, s[76:79], 0 offen offset:0
    buffer_load_ushort v21, v17, s[76:79], 0 offen offset:64
    s_mov_b32 s76, s26
    s_and_b32 s77, s27, 0xffff
    buffer_load_ushort v19, v17, s[76:79], 0 offen offset:0
    buffer_load_ushort v22, v17, s[76:79], 0 offen offset:64
    s_cmp_lg_u32 s93, 0
    s_cselect_b32 s48, s18, s6
    s_cselect_b32 s49, s19, s7
    s_cselect_b32 s52, s20, s6
    s_cselect_b32 s53, s21, s7
    s_cselect_b32 s38, 0, 1024
    s_and_b32 s49, s49, 0xffff
    s_and_b32 s53, s53, 0xffff
    s_lshl_b32 s39, s80, 11
    s_add_u32 m0, s39, 16384
    s_nop 0
    buffer_load_dwordx4 v14, s[48:51], s87 offen offset:0 lds
    buffer_load_dwordx4 v15, s[48:51], s87 offen offset:1024 lds
    s_add_u32 s87, s87, s38
    s_add_u32 m0, s39, 24576
    s_nop 0
    buffer_load_dwordx4 v14, s[52:55], s87 offen offset:0 lds
    buffer_load_dwordx4 v15, s[52:55], s87 offen offset:1024 lds
    s_mov_b32 s89, s38
    s_lshl_b32 s38, s82, 11
    s_and_b32 s39, s80, 1
    s_lshl_b32 s39, s39, 10
    s_add_u32 s38, s38, s39
    s_mov_b32 s78, 1024
    s_mov_b32 s86, 155648
    s_cmp_lt_u32 s80, 2
    s_cselect_b32 s76, s30, s8
    s_cselect_b32 s77, s31, s9
    s_cselect_b32 s78, s78, 16384
    s_cselect_b32 s38, 0, s38
    s_cselect_b32 s86, s86, 159744
    s_and_b32 s77, s77, 0xffff
    s_mov_b32 s79, 0x20000
    s_add_u32 m0, s86, s39
    s_nop 0
    buffer_load_dwordx4 v18, s[76:79], s38 offen lds
    s_mov_b32 s56, s36
    s_and_b32 s57, s37, 0xffff
    s_mov_b32 s58, 268435456
    s_mov_b32 s59, 0x20000
    s_mov_b32 s72, s32
    s_and_b32 s73, s33, 0xffff
    s_mov_b32 s74, 4194304
    s_mov_b32 s75, 0x20000
    v_mov_b32 v17, 0
    buffer_load_dword v17, v17, s[56:59], 0 offen offset:0 sc1
    s_mov_b32 s30, s89
    s_mov_b32 s35, s88
    s_lshl_b32 s31, s80, 12
    s_lshl_b32 s34, s80, 11
    s_add_u32 s85, s85, 1
    s_and_b32 s85, s85, 7
    s_cmp_lg_u32 s93, 0
    s_cbranch_scc1 gm_PATHB
    s_mov_b32 s68, s24
    s_and_b32 s69, s25, 0xffff
    s_mov_b32 s70, 524288
    s_mov_b32 s71, 0x20000
    v_mov_b32 v24, -1
    v_mov_b32 v25, -1
    v_mov_b32 v26, -1
    v_mov_b32 v27, -1
    s_lshl_b32 s38, s81, 2
    s_add_u32 s38, s38, s80
    s_mul_i32 s38, s38, 98304
    s_add_u32 s24, s38, 2097152
    s_lshl_b32 s89, s82, 12
    s_add_u32 s89, s89, s24
    s_add_u32 s89, s89, 65536
    s_lshr_b32 s88, s2, 3
    s_add_u32 s88, s88, s80
    s_and_b32 s88, s88, 7
    s_lshl_b32 s88, s88, 10
    s_lshl_b32 s38, s82, 2
    s_add_u32 s38, s38, s80
    s_lshl_b32 s38, s38, 4
    s_add_u32 s38, s38, s81
    s_lshl_b32 s39, s38, 10
    s_add_u32 s39, s39, 65536
    s_lshl_b32 s38, s38, 6
    s_add_u32 s38, s38, 589824
    v_lshlrev_b32 v23, 8, v6
    v_lshl_add_u32 v23, v8, 4, v23
    v_add_u32 v23, s39, v23
    v_lshlrev_b32 v28, 4, v6
    v_add_u32 v28, s38, v28
    s_and_b32 s39, s80, 1
    v_and_b32 v29, 1, v7
    v_cmp_eq_u32 vcc, s39, v29
    s_nop 1
    v_cndmask_b32 v29, v28, v23, vcc
    v_add_u32 v23, 512, v23
    v_add_u32 v28, 32, v28
    v_cndmask_b32 v30, v28, v23, vcc
    v_lshlrev_b32 v31, 2, v5
    s_lshl_b32 s38, s81, 9
    s_lshl_b32 s39, s80, 7
    s_add_u32 s38, s38, s39
    s_add_u32 s38, s38, 720896
    s_cmp_eq_u32 s82, 0
    s_cselect_b32 s27, s38, 2147418112
    s_lshl_b32 s38, s2, 2
    s_add_u32 s38, s38, 4096
    s_cmp_eq_u32 s80, 0
    s_cselect_b32 s26, s38, 2147418112
    s_mov_b32 s44, s6
    s_and_b32 s45, s7, 0xffff
    s_mov_b32 s46, 1572864
    s_mov_b32 s47, 0x20000
    s_mov_b32 s60, s10
    s_and_b32 s61, s11, 0xffff
    s_mov_b32 s62, 524288
    s_mov_b32 s63, 0x20000
    s_mov_b32 s64, s22
    s_and_b32 s65, s23, 0xffff
    s_mov_b32 s66, 524288
    s_mov_b32 s67, 0x20000
    s_lshl_b32 s36, s94, 10
    s_lshl_b32 s38, s80, 8
    s_add_u32 s36, s36, s38
    s_lshl_b32 s37, s80, 17
    s_lshl_b32 s38, s94, 1
    s_add_u32 s37, s37, s38
    s_lshl_b32 s32, s85, 7
    s_add_u32 s32, s32, s90
    s_add_u32 m0, s31, 32768
    s_mul_i32 s33, s85, s3
    buffer_load_dwordx4 v9, s[40:43], s32 offen offset:0 lds
    buffer_load_dwordx4 v10, s[40:43], s32 offen offset:1024 lds
    buffer_load_dwordx4 v11, s[40:43], s32 offen offset:2048 lds
    buffer_load_dwordx4 v12, s[40:43], s32 offen offset:3072 lds
    v_bfe_u32 v23, v5, 2, 1
    v_lshlrev_b32 v32, 4, v23
    v_and_b32 v23, 1, v5
    v_lshl_or_b32 v32, v23, 3, v32
    v_lshrrev_b32 v23, 3, v5
    v_lshl_or_b32 v32, v23, 1, v32
    v_bfe_u32 v23, v5, 1, 1
    v_or_b32 v32, v32, v23
    v_bfe_u32 v23, v32, 1, 3
    v_xor_b32 v23, v23, v6
    v_lshlrev_b32 v23, 4, v23
    v_lshl_add_u32 v33, v32, 7, v23
    s_lshl_b32 s38, s80, 12
    v_add_u32 v33, s38, v33
    v_xor_b32 v34, 32, v33
    v_xor_b32 v35, 64, v33
    v_xor_b32 v36, 96, v33
    v_bfe_u32 v23, v5, 1, 3
    v_xor_b32 v23, v23, v6
    v_lshlrev_b32 v23, 4, v23
    v_lshl_add_u32 v37, v5, 7, v23
    v_and_b32 v38, 0x13, v5
    v_bfe_u32 v23, v5, 2, 1
    v_lshl_or_b32 v38, v23, 3, v38
    v_bfe_u32 v23, v5, 3, 1
    v_lshl_or_b32 v38, v23, 2, v38
    v_lshrrev_b32 v40, 2, v8
    v_and_b32 v41, 3, v0
    v_lshrrev_b32 v23, 1, v41
    v_and_b32 v28, 1, v41
    v_lshl_or_b32 v42, v28, 1, v23
    v_and_b32 v23, 1, v7
    v_lshlrev_b32 v23, 5, v23
    v_lshl_add_u32 v23, v41, 3, v23
    v_lshrrev_b32 v28, 1, v40
    v_lshlrev_b32 v28, 6, v28
    v_xor_b32 v23, v23, v28
    v_lshl_add_u32 v28, v6, 3, v40
    v_lshl_add_u32 v39, v28, 7, v23
    v_mov_b32 v43, v39
    v_xor_b32 v44, 64, v39
    v_and_b32 v23, 1, v7
    v_lshlrev_b32 v23, 5, v23
    v_lshl_add_u32 v23, v42, 3, v23
    v_lshrrev_b32 v28, 1, v40
    v_lshlrev_b32 v28, 6, v28
    v_xor_b32 v23, v23, v28
    v_lshl_add_u32 v28, v6, 3, v40
    v_lshl_add_u32 v45, v28, 7, v23
    v_xor_b32 v46, 64, v45
    v_xor_b32 v47, 0x10000, v33
    v_xor_b32 v48, 0x10000, v34
    v_xor_b32 v49, 0x10000, v35
    v_xor_b32 v50, 0x10000, v36
    v_xor_b32 v51, 0x10000, v43
    v_xor_b32 v52, 0x10000, v44
    v_xor_b32 v53, 0x10000, v45
    v_xor_b32 v54, 0x10000, v46
    v_bfe_u32 v23, v8, 2, 1
    v_and_b32 v28, 1, v7
    v_cmp_eq_u32 vcc, v23, v28
    s_lshl_b32 s38, s83, 7
    s_add_u32 s38, s38, 155648
    v_lshlrev_b32 v23, 4, v6
    v_lshl_add_u32 v23, v41, 5, v23
    v_add_u32 v23, s38, v23
    v_mov_b32 v28, 157760
    v_cndmask_b32 v55, v28, v23, vcc
    v_mov_b32 v56, 0
    v_mov_b32 v57, 0
    s_lshl_b32 s38, s80, 9
    s_add_u32 s38, s38, 157696
    v_lshlrev_b32 v23, 3, v0
    v_add_u32 v23, s38, v23
    ds_write_b64 v23, v[56:57]
    v_lshl_add_u32 v28, v6, 3, v40
    v_and_b32 v23, 1, v7
    v_lshlrev_b32 v23, 5, v23
    v_lshl_add_u32 v23, v41, 3, v23
    v_lshl_add_u32 v56, v28, 6, v23
    v_lshl_add_u32 v57, v1, 10, v2
    v_lshrrev_b32 v23, 2, v0
    s_lshl_b32 s38, s80, 4
    v_add_u32 v23, s38, v23
    v_mul_u32_u24 v23, 3072, v23
    v_and_b32 v28, 3, v0
    v_lshl_add_u32 v23, v28, 4, v23
    s_lshl_b32 s38, s82, 7
    s_lshl_b32 s39, s93, 6
    s_add_u32 s38, s38, s39
    v_add_u32 v23, s38, v23
    v_cmp_eq_u32 vcc, 0, v0
    v_mov_b32 v28, 2147418112
    s_nop 0
    v_cndmask_b32 v63, v28, v0, vcc
    v_lshl_add_u32 v28, v6, 2, v40
    v_lshlrev_b32 v28, 5, v28
    v_and_b32 v62, 1, v7
    v_lshl_add_u32 v28, v62, 4, v28
    v_lshrrev_b32 v62, 1, v41
    v_lshl_add_u32 v28, v62, 3, v28
    v_add_u32 v65, 159744, v28
    v_bfe_u32 v66, v5, 2, 1
    v_mul_u32_u24 v66, 0x8000, v66
    v_lshl_or_b32 v66, v66, 16, v66
    v_and_b32 v28, 1, v0
    v_lshlrev_b32 v28, 4, v28
    v_mov_b32 v62, 0x3f80
    v_lshlrev_b32 v28, v28, v62
    v_lshrrev_b32 v62, 3, v0
    v_xor_b32 v62, v62, v7
    v_and_b32 v62, 1, v62
    v_lshlrev_b32 v62, 2, v62
    v_bfe_u32 v68, v0, 1, 2
    v_or_b32 v62, v62, v68
    v_cmp_eq_u32 vcc, 0, v62
    s_nop 1
    v_cndmask_b32 v68, 0, v28, vcc
    v_cmp_eq_u32 vcc, 1, v62
    s_nop 1
    v_cndmask_b32 v69, 0, v28, vcc
    v_cmp_eq_u32 vcc, 2, v62
    s_nop 1
    v_cndmask_b32 v70, 0, v28, vcc
    v_cmp_eq_u32 vcc, 3, v62
    s_nop 1
    v_cndmask_b32 v71, 0, v28, vcc
    s_add_u32 m0, s34, 49152
    s_add_u32 s33, s33, s91
    buffer_load_dwordx4 v14, s[48:51], s33 offen offset:0 lds
    buffer_load_dwordx4 v15, s[48:51], s33 offen offset:1024 lds
    s_add_u32 m0, s34, 57344
    s_add_u32 s33, s33, s30
    buffer_load_dwordx4 v14, s[52:55], s33 offen offset:0 lds
    buffer_load_dwordx4 v15, s[52:55], s33 offen offset:1024 lds
    s_add_u32 s85, s85, 1
    s_and_b32 s85, s85, 7
    buffer_store_dwordx4 v[24:27], v29, s[56:59], 0 offen sc1
    buffer_store_dwordx4 v[24:27], v30, s[56:59], 0 offen sc1
    buffer_store_dword v24, v31, s[56:59], s27 offen sc1
    s_waitcnt vmcnt(12) lgkmcnt(0)
    s_barrier
    ds_read_b128 a[0:3], v33 offset:0
    ds_read_b64_tr_b16 v[152:153], v43 offset:16384
    ds_read_b64_tr_b16 v[154:155], v43 offset:16896
    ds_read_b64_tr_b16 v[156:157], v44 offset:16384
    ds_read_b64_tr_b16 v[158:159], v44 offset:16896
    ds_read_b64_tr_b16 v[160:161], v45 offset:24576
    ds_read_b64_tr_b16 v[162:163], v45 offset:25088
    ds_read_b64_tr_b16 v[164:165], v46 offset:24576
    ds_read_b64_tr_b16 v[166:167], v46 offset:25088
    ds_read_b128 v[184:187], v55 offset:0
    ds_read_b128 a[4:7], v34 offset:0
    ds_read_b64_tr_b16 v[168:169], v43 offset:18432
    s_waitcnt lgkmcnt(9)
    v_mfma_f32_32x32x16_bf16 v[72:87], v[152:155], a[0:3], 0
    s_lshl_b32 s32, s85, 7
    s_add_u32 s32, s32, s90
    s_add_u32 m0, s31, 65536
    s_mul_i32 s33, s85, s3
    buffer_load_dwordx4 v9, s[40:43], s32 offen offset:0 lds
    ds_read_b64_tr_b16 v[170:171], v43 offset:18944
    ds_read_b64_tr_b16 v[172:173], v44 offset:18432
    s_waitcnt lgkmcnt(9)
    v_mfma_f32_32x32x16_bf16 v[88:103], v[156:159], a[0:3], 0
    ds_read_b64_tr_b16 v[174:175], v44 offset:18944
    ds_read_b64_tr_b16 v[176:177], v45 offset:26624
    s_waitcnt lgkmcnt(9)
    v_mfma_f32_32x32x16_bf16 v[104:119], a[0:3], v[160:163], 0
    buffer_load_dwordx4 v10, s[40:43], s32 offen offset:1024 lds
    ds_read_b64_tr_b16 v[178:179], v45 offset:27136
    ds_read_b64_tr_b16 v[180:181], v46 offset:26624
    s_waitcnt lgkmcnt(9)
    v_mfma_f32_32x32x16_bf16 v[120:135], a[0:3], v[164:167], 0
    ds_read_b64_tr_b16 v[182:183], v46 offset:27136
    s_waitcnt lgkmcnt(9)
    v_mfma_f32_16x16x32_bf16 v[136:139], v[184:187], a[0:3], 0
    ds_read_b128 a[8:11], v35 offset:0
    ds_read_b64_tr_b16 v[152:153], v43 offset:20480
    s_waitcnt lgkmcnt(8)
    v_mfma_f32_32x32x16_bf16 v[72:87], v[168:171], a[4:7], v[72:87]
    buffer_load_dwordx4 v11, s[40:43], s32 offen offset:2048 lds
    ds_read_b64_tr_b16 v[154:155], v43 offset:20992
    ds_read_b64_tr_b16 v[156:157], v44 offset:20480
    s_waitcnt lgkmcnt(8)
    v_mfma_f32_32x32x16_bf16 v[88:103], v[172:175], a[4:7], v[88:103]
    ds_read_b64_tr_b16 v[158:159], v44 offset:20992
    ds_read_b64_tr_b16 v[160:161], v45 offset:28672
    s_waitcnt lgkmcnt(8)
    v_mfma_f32_32x32x16_bf16 v[104:119], a[4:7], v[176:179], v[104:119]
    buffer_load_dwordx4 v12, s[40:43], s32 offen offset:3072 lds
    ds_read_b64_tr_b16 v[162:163], v45 offset:29184
    ds_read_b64_tr_b16 v[164:165], v46 offset:28672
    s_waitcnt lgkmcnt(8)
    v_mfma_f32_32x32x16_bf16 v[120:135], a[4:7], v[180:183], v[120:135]
    ds_read_b64_tr_b16 v[166:167], v46 offset:29184
    v_mfma_f32_16x16x32_bf16 v[140:143], v[184:187], a[4:7], 0
    ds_read_b128 a[12:15], v36 offset:0
    ds_read_b64_tr_b16 v[168:169], v43 offset:22528
    s_waitcnt lgkmcnt(8)
    v_mfma_f32_32x32x16_bf16 v[72:87], v[152:155], a[8:11], v[72:87]
    s_add_u32 m0, s34, 81920
    s_add_u32 s33, s33, s91
    buffer_load_dwordx4 v14, s[48:51], s33 offen offset:0 lds
    ds_read_b64_tr_b16 v[170:171], v43 offset:23040
    ds_read_b64_tr_b16 v[172:173], v44 offset:22528
    s_waitcnt lgkmcnt(8)
    v_mfma_f32_32x32x16_bf16 v[88:103], v[156:159], a[8:11], v[88:103]
    ds_read_b64_tr_b16 v[174:175], v44 offset:23040
    ds_read_b64_tr_b16 v[176:177], v45 offset:30720
    s_waitcnt lgkmcnt(8)
    v_mfma_f32_32x32x16_bf16 v[104:119], a[8:11], v[160:163], v[104:119]
    buffer_load_dwordx4 v15, s[48:51], s33 offen offset:1024 lds
    ds_read_b64_tr_b16 v[178:179], v45 offset:31232
    ds_read_b64_tr_b16 v[180:181], v46 offset:30720
    s_waitcnt lgkmcnt(8)
    v_mfma_f32_32x32x16_bf16 v[120:135], a[8:11], v[164:167], v[120:135]
    ds_read_b64_tr_b16 v[182:183], v46 offset:31232
    v_mfma_f32_16x16x32_bf16 v[144:147], v[184:187], a[8:11], 0
    s_waitcnt lgkmcnt(6)
    v_mfma_f32_32x32x16_bf16 v[72:87], v[168:171], a[12:15], v[72:87]
    ds_read_b64_tr_b16 v[192:193], v65 offset:0
    ds_read_b64_tr_b16 v[194:195], v65 offset:256
    ds_read_b64_tr_b16 v[196:197], v65 offset:512
    ds_read_b64_tr_b16 v[198:199], v65 offset:768
    ds_read_b64_tr_b16 v[200:201], v65 offset:1024
    ds_read_b64_tr_b16 v[202:203], v65 offset:1280
    ds_read_b64_tr_b16 v[204:205], v65 offset:1536
    ds_read_b64_tr_b16 v[206:207], v65 offset:1792
    s_waitcnt vmcnt(17)
    v_readfirstlane_b32 s84, v17
    s_nop 0
    s_mul_i32 s84, s84, 0x9E3779B1
    s_add_u32 s84, s84, 0x7F4A7C15
    v_mov_b32 v17, s84
    s_mov_b32 s0, s84
    s_mov_b32 s1, s84
    s_waitcnt lgkmcnt(7)
    v_xor_b32 v192, v192, v66
    v_xor_b32 v193, v193, v66
    s_waitcnt lgkmcnt(6)
    v_xor_b32 v194, v194, v66
    v_xor_b32 v195, v195, v66
    s_waitcnt lgkmcnt(5)
    v_xor_b32 v196, v196, v66
    v_xor_b32 v197, v197, v66
    s_waitcnt lgkmcnt(4)
    v_xor_b32 v198, v198, v66
    v_xor_b32 v199, v199, v66
    s_waitcnt lgkmcnt(3)
    v_xor_b32 v200, v200, v66
    v_xor_b32 v201, v201, v66
    s_waitcnt lgkmcnt(2)
    v_xor_b32 v202, v202, v66
    v_xor_b32 v203, v203, v66
    s_waitcnt lgkmcnt(1)
    v_xor_b32 v204, v204, v66
    v_xor_b32 v205, v205, v66
    s_waitcnt lgkmcnt(0)
    v_xor_b32 v206, v206, v66
    v_xor_b32 v207, v207, v66
    s_waitcnt vmcnt(9)
    s_barrier
    ds_read_b128 a[16:19], v33 offset:32768
    ds_read_b64_tr_b16 v[152:153], v43 offset:49152
    ds_read_b64_tr_b16 v[154:155], v43 offset:49664
    ds_read_b64_tr_b16 v[156:157], v44 offset:49152
    v_mfma_f32_32x32x16_bf16 v[88:103], v[172:175], a[12:15], v[88:103]
    ds_read_b64_tr_b16 v[158:159], v44 offset:49664
    ds_read_b64_tr_b16 v[160:161], v45 offset:57344
    ds_read_b64_tr_b16 v[162:163], v45 offset:57856
    ds_read_b64_tr_b16 v[164:165], v46 offset:57344
    v_mfma_f32_32x32x16_bf16 v[104:119], a[12:15], v[176:179], v[104:119]
    s_add_u32 m0, s34, 90112
    s_add_u32 s33, s33, s30
    buffer_load_dwordx4 v14, s[52:55], s33 offen offset:0 lds
    ds_read_b64_tr_b16 v[166:167], v46 offset:57856
    ds_read_b128 v[188:191], v55 offset:128
    v_mfma_f32_32x32x16_bf16 v[120:135], a[12:15], v[180:183], v[120:135]
    buffer_load_dwordx4 v15, s[52:55], s33 offen offset:1024 lds
    s_add_u32 s85, s85, 1
    s_and_b32 s85, s85, 7
    v_mfma_f32_16x16x32_bf16 v[148:151], v[184:187], a[12:15], 0
    ds_read_b128 a[20:23], v34 offset:32768
    ds_read_b64_tr_b16 v[168:169], v43 offset:51200
    s_waitcnt lgkmcnt(9)
    v_mfma_f32_32x32x16_bf16 v[72:87], v[152:155], a[16:19], v[72:87]
    s_lshl_b32 s32, s85, 7
    s_add_u32 s32, s32, s90
    s_add_u32 m0, s31, 98304
    s_mul_i32 s33, s85, s3
    buffer_load_dwordx4 v9, s[40:43], s32 offen offset:0 lds
    ds_read_b64_tr_b16 v[170:171], v43 offset:51712
    ds_read_b64_tr_b16 v[172:173], v44 offset:51200
    s_waitcnt lgkmcnt(9)
    v_mfma_f32_32x32x16_bf16 v[88:103], v[156:159], a[16:19], v[88:103]
    ds_read_b64_tr_b16 v[174:175], v44 offset:51712
    ds_read_b64_tr_b16 v[176:177], v45 offset:59392
    s_waitcnt lgkmcnt(9)
    v_mfma_f32_32x32x16_bf16 v[104:119], a[16:19], v[160:163], v[104:119]
    buffer_load_dwordx4 v10, s[40:43], s32 offen offset:1024 lds
    ds_read_b64_tr_b16 v[178:179], v45 offset:59904
    ds_read_b64_tr_b16 v[180:181], v46 offset:59392
    s_waitcnt lgkmcnt(9)
    v_mfma_f32_32x32x16_bf16 v[120:135], a[16:19], v[164:167], v[120:135]
    ds_read_b64_tr_b16 v[182:183], v46 offset:59904
    s_waitcnt lgkmcnt(9)
    v_mfma_f32_16x16x32_bf16 v[136:139], v[188:191], a[16:19], v[136:139]
    ds_read_b128 a[24:27], v35 offset:32768
    ds_read_b64_tr_b16 v[152:153], v43 offset:53248
    s_waitcnt lgkmcnt(8)
    v_mfma_f32_32x32x16_bf16 v[72:87], v[168:171], a[20:23], v[72:87]
    buffer_load_dwordx4 v11, s[40:43], s32 offen offset:2048 lds
    ds_read_b64_tr_b16 v[154:155], v43 offset:53760
    ds_read_b64_tr_b16 v[156:157], v44 offset:53248
    s_waitcnt lgkmcnt(8)
    v_mfma_f32_32x32x16_bf16 v[88:103], v[172:175], a[20:23], v[88:103]
    ds_read_b64_tr_b16 v[158:159], v44 offset:53760
    ds_read_b64_tr_b16 v[160:161], v45 offset:61440
    s_waitcnt lgkmcnt(8)
    v_mfma_f32_32x32x16_bf16 v[104:119], a[20:23], v[176:179], v[104:119]
    buffer_load_dwordx4 v12, s[40:43], s32 offen offset:3072 lds
    ds_read_b64_tr_b16 v[162:163], v45 offset:61952
    ds_read_b64_tr_b16 v[164:165], v46 offset:61440
    s_waitcnt lgkmcnt(8)
    v_mfma_f32_32x32x16_bf16 v[120:135], a[20:23], v[180:183], v[120:135]
    ds_read_b64_tr_b16 v[166:167], v46 offset:61952
    v_mfma_f32_16x16x32_bf16 v[140:143], v[188:191], a[20:23], v[140:143]
    ds_read_b128 a[28:31], v36 offset:32768
    ds_read_b64_tr_b16 v[168:169], v43 offset:55296
    s_waitcnt lgkmcnt(8)
    v_mfma_f32_32x32x16_bf16 v[72:87], v[152:155], a[24:27], v[72:87]
    s_add_u32 m0, s34, 114688
    s_add_u32 s33, s33, s91
    buffer_load_dwordx4 v14, s[48:51], s33 offen offset:0 lds
    ds_read_b64_tr_b16 v[170:171], v43 offset:55808
    ds_read_b64_tr_b16 v[172:173], v44 offset:55296
    s_waitcnt lgkmcnt(8)
    v_mfma_f32_32x32x16_bf16 v[88:103], v[156:159], a[24:27], v[88:103]
    ds_read_b64_tr_b16 v[174:175], v44 offset:55808
    ds_read_b64_tr_b16 v[176:177], v45 offset:63488
    s_waitcnt lgkmcnt(8)
    v_mfma_f32_32x32x16_bf16 v[104:119], a[24:27], v[160:163], v[104:119]
    buffer_load_dwordx4 v15, s[48:51], s33 offen offset:1024 lds
    ds_read_b64_tr_b16 v[178:179], v45 offset:64000
    ds_read_b64_tr_b16 v[180:181], v46 offset:63488
    s_waitcnt lgkmcnt(8)
    v_mfma_f32_32x32x16_bf16 v[120:135], a[24:27], v[164:167], v[120:135]
    ds_read_b64_tr_b16 v[182:183], v46 offset:64000
    v_mfma_f32_16x16x32_bf16 v[144:147], v[188:191], a[24:27], v[144:147]
    s_waitcnt lgkmcnt(6)
    v_mfma_f32_32x32x16_bf16 v[72:87], v[168:171], a[28:31], v[72:87]
    s_waitcnt vmcnt(6)
    s_barrier
    buffer_store_dword v17, v63, s[56:59], s26 offen sc1
    ds_read_b128 a[32:35], v47 offset:0
    ds_read_b64_tr_b16 v[152:153], v51 offset:16384
    ds_read_b64_tr_b16 v[154:155], v51 offset:16896
    ds_read_b64_tr_b16 v[156:157], v52 offset:16384
    s_waitcnt lgkmcnt(8)
    v_mfma_f32_32x32x16_bf16 v[88:103], v[172:175], a[28:31], v[88:103]
    ds_read_b64_tr_b16 v[158:159], v52 offset:16896
    ds_read_b64_tr_b16 v[160:161], v53 offset:24576
    ds_read_b64_tr_b16 v[162:163], v53 offset:25088
    ds_read_b64_tr_b16 v[164:165], v54 offset:24576
    s_waitcnt lgkmcnt(10)
    v_mfma_f32_32x32x16_bf16 v[104:119], a[28:31], v[176:179], v[104:119]
    s_add_u32 m0, s34, 122880
    s_add_u32 s33, s33, s30
    buffer_load_dwordx4 v14, s[52:55], s33 offen offset:0 lds
    ds_read_b64_tr_b16 v[166:167], v54 offset:25088
    ds_read_b128 v[184:187], v55 offset:256
    s_waitcnt lgkmcnt(10)
    v_mfma_f32_32x32x16_bf16 v[120:135], a[28:31], v[180:183], v[120:135]
    buffer_load_dwordx4 v15, s[52:55], s33 offen offset:1024 lds
    s_add_u32 s85, s85, 1
    s_and_b32 s85, s85, 7
    v_mfma_f32_16x16x32_bf16 v[148:151], v[188:191], a[28:31], v[148:151]
    ds_read_b128 a[36:39], v48 offset:0
    ds_read_b64_tr_b16 v[168:169], v51 offset:18432
    s_waitcnt lgkmcnt(9)
    v_mfma_f32_32x32x16_bf16 v[72:87], v[152:155], a[32:35], v[72:87]
    buffer_store_dwordx4 v[24:27], v18, s[56:59], s89 offen offset:0 sc1
    s_lshl_b32 s32, s85, 7
    s_add_u32 s32, s32, s90
    s_add_u32 m0, s31, 0
    s_mul_i32 s33, s85, s3
    buffer_load_dwordx4 v9, s[40:43], s32 offen offset:0 lds
    ds_read_b64_tr_b16 v[170:171], v51 offset:18944
    ds_read_b64_tr_b16 v[172:173], v52 offset:18432
    s_waitcnt lgkmcnt(9)
    v_mfma_f32_32x32x16_bf16 v[88:103], v[156:159], a[32:35], v[88:103]
    ds_read_b64_tr_b16 v[174:175], v52 offset:18944
    ds_read_b64_tr_b16 v[176:177], v53 offset:26624
    s_waitcnt lgkmcnt(9)
    v_mfma_f32_32x32x16_bf16 v[104:119], a[32:35], v[160:163], v[104:119]
    buffer_load_dwordx4 v10, s[40:43], s32 offen offset:1024 lds
    ds_read_b64_tr_b16 v[178:179], v53 offset:27136
    ds_read_b64_tr_b16 v[180:181], v54 offset:26624
    s_waitcnt lgkmcnt(9)
    v_mfma_f32_32x32x16_bf16 v[120:135], a[32:35], v[164:167], v[120:135]
    ds_read_b64_tr_b16 v[182:183], v54 offset:27136
    s_waitcnt lgkmcnt(9)
    v_mfma_f32_16x16x32_bf16 v[136:139], v[184:187], a[32:35], v[136:139]
    ds_read_b128 a[40:43], v49 offset:0
    ds_read_b64_tr_b16 v[152:153], v51 offset:20480
    s_waitcnt lgkmcnt(8)
    v_mfma_f32_32x32x16_bf16 v[72:87], v[168:171], a[36:39], v[72:87]
    buffer_load_dwordx4 v11, s[40:43], s32 offen offset:2048 lds
    ds_read_b64_tr_b16 v[154:155], v51 offset:20992
    ds_read_b64_tr_b16 v[156:157], v52 offset:20480
    s_waitcnt lgkmcnt(8)
    v_mfma_f32_32x32x16_bf16 v[88:103], v[172:175], a[36:39], v[88:103]
    ds_read_b64_tr_b16 v[158:159], v52 offset:20992
    ds_read_b64_tr_b16 v[160:161], v53 offset:28672
    s_waitcnt lgkmcnt(8)
    v_mfma_f32_32x32x16_bf16 v[104:119], a[36:39], v[176:179], v[104:119]
    buffer_load_dwordx4 v12, s[40:43], s32 offen offset:3072 lds
    ds_read_b64_tr_b16 v[162:163], v53 offset:29184
    ds_read_b64_tr_b16 v[164:165], v54 offset:28672
    s_waitcnt lgkmcnt(8)
    v_mfma_f32_32x32x16_bf16 v[120:135], a[36:39], v[180:183], v[120:135]
    ds_read_b64_tr_b16 v[166:167], v54 offset:29184
    v_mfma_f32_16x16x32_bf16 v[140:143], v[184:187], a[36:39], v[140:143]
    ds_read_b128 a[44:47], v50 offset:0
    ds_read_b64_tr_b16 v[168:169], v51 offset:22528
    s_waitcnt lgkmcnt(8)
    v_mfma_f32_32x32x16_bf16 v[72:87], v[152:155], a[40:43], v[72:87]
    s_add_u32 m0, s34, 16384
    s_add_u32 s33, s33, s91
    buffer_load_dwordx4 v14, s[48:51], s33 offen offset:0 lds
    ds_read_b64_tr_b16 v[170:171], v51 offset:23040
    ds_read_b64_tr_b16 v[172:173], v52 offset:22528
    s_waitcnt lgkmcnt(8)
    v_mfma_f32_32x32x16_bf16 v[88:103], v[156:159], a[40:43], v[88:103]
    ds_read_b64_tr_b16 v[174:175], v52 offset:23040
    ds_read_b64_tr_b16 v[176:177], v53 offset:30720
    s_waitcnt lgkmcnt(8)
    v_mfma_f32_32x32x16_bf16 v[104:119], a[40:43], v[160:163], v[104:119]
    buffer_load_dwordx4 v15, s[48:51], s33 offen offset:1024 lds
    ds_read_b64_tr_b16 v[178:179], v53 offset:31232
    ds_read_b64_tr_b16 v[180:181], v54 offset:30720
    s_waitcnt lgkmcnt(8)
    v_mfma_f32_32x32x16_bf16 v[120:135], a[40:43], v[164:167], v[120:135]
    ds_read_b64_tr_b16 v[182:183], v54 offset:31232
    v_mfma_f32_16x16x32_bf16 v[144:147], v[184:187], a[40:43], v[144:147]
    s_waitcnt lgkmcnt(6)
    v_mfma_f32_32x32x16_bf16 v[72:87], v[168:171], a[44:47], v[72:87]
    s_waitcnt vmcnt(7)
    s_barrier
    ds_read_b128 a[48:51], v47 offset:32768
    ds_read_b64_tr_b16 v[152:153], v51 offset:49152
    ds_read_b64_tr_b16 v[154:155], v51 offset:49664
    ds_read_b64_tr_b16 v[156:157], v52 offset:49152
    s_waitcnt lgkmcnt(8)
    v_mfma_f32_32x32x16_bf16 v[88:103], v[172:175], a[44:47], v[88:103]
    ds_read_b64_tr_b16 v[158:159], v52 offset:49664
    ds_read_b64_tr_b16 v[160:161], v53 offset:57344
    ds_read_b64_tr_b16 v[162:163], v53 offset:57856
    ds_read_b64_tr_b16 v[164:165], v54 offset:57344
    s_waitcnt lgkmcnt(10)
    v_mfma_f32_32x32x16_bf16 v[104:119], a[44:47], v[176:179], v[104:119]
    s_add_u32 m0, s34, 24576
    s_add_u32 s33, s33, s30
    buffer_load_dwordx4 v14, s[52:55], s33 offen offset:0 lds
    ds_read_b64_tr_b16 v[166:167], v54 offset:57856
    ds_read_b128 v[188:191], v55 offset:384
    s_waitcnt lgkmcnt(10)
    v_mfma_f32_32x32x16_bf16 v[120:135], a[44:47], v[180:183], v[120:135]
    buffer_load_dwordx4 v15, s[52:55], s33 offen offset:1024 lds
    s_add_u32 s85, s85, 1
    s_and_b32 s85, s85, 7
    v_mfma_f32_16x16x32_bf16 v[148:151], v[184:187], a[44:47], v[148:151]
    ds_read_b128 a[52:55], v48 offset:32768
    ds_read_b64_tr_b16 v[168:169], v51 offset:51200
    s_waitcnt lgkmcnt(9)
    v_mfma_f32_32x32x16_bf16 v[72:87], v[152:155], a[48:51], v[72:87]
    buffer_store_dwordx4 v[24:27], v18, s[56:59], s89 offen offset:1024 sc1
    s_lshl_b32 s32, s85, 7
    s_add_u32 s32, s32, s90
    s_add_u32 m0, s31, 32768
    s_mul_i32 s33, s85, s3
    buffer_load_dwordx4 v9, s[40:43], s32 offen offset:0 lds
    ds_read_b64_tr_b16 v[170:171], v51 offset:51712
    ds_read_b64_tr_b16 v[172:173], v52 offset:51200
    s_waitcnt lgkmcnt(9)
    v_mfma_f32_32x32x16_bf16 v[88:103], v[156:159], a[48:51], v[88:103]
    ds_read_b64_tr_b16 v[174:175], v52 offset:51712
    ds_read_b64_tr_b16 v[176:177], v53 offset:59392
    s_waitcnt lgkmcnt(9)
    v_mfma_f32_32x32x16_bf16 v[104:119], a[48:51], v[160:163], v[104:119]
    buffer_load_dwordx4 v10, s[40:43], s32 offen offset:1024 lds
    ds_read_b64_tr_b16 v[178:179], v53 offset:59904
    ds_read_b64_tr_b16 v[180:181], v54 offset:59392
    s_waitcnt lgkmcnt(9)
    v_mfma_f32_32x32x16_bf16 v[120:135], a[48:51], v[164:167], v[120:135]
    ds_read_b64_tr_b16 v[182:183], v54 offset:59904
    s_waitcnt lgkmcnt(9)
    v_mfma_f32_16x16x32_bf16 v[136:139], v[188:191], a[48:51], v[136:139]
    ds_read_b128 a[56:59], v49 offset:32768
    ds_read_b64_tr_b16 v[152:153], v51 offset:53248
    s_waitcnt lgkmcnt(8)
    v_mfma_f32_32x32x16_bf16 v[72:87], v[168:171], a[52:55], v[72:87]
    buffer_load_dwordx4 v11, s[40:43], s32 offen offset:2048 lds
    ds_read_b64_tr_b16 v[154:155], v51 offset:53760
    ds_read_b64_tr_b16 v[156:157], v52 offset:53248
    s_waitcnt lgkmcnt(8)
    v_mfma_f32_32x32x16_bf16 v[88:103], v[172:175], a[52:55], v[88:103]
    ds_read_b64_tr_b16 v[158:159], v52 offset:53760
    ds_read_b64_tr_b16 v[160:161], v53 offset:61440
    s_waitcnt lgkmcnt(8)
    v_mfma_f32_32x32x16_bf16 v[104:119], a[52:55], v[176:179], v[104:119]
    buffer_load_dwordx4 v12, s[40:43], s32 offen offset:3072 lds
    ds_read_b64_tr_b16 v[162:163], v53 offset:61952
    ds_read_b64_tr_b16 v[164:165], v54 offset:61440
    s_waitcnt lgkmcnt(8)
    v_mfma_f32_32x32x16_bf16 v[120:135], a[52:55], v[180:183], v[120:135]
    ds_read_b64_tr_b16 v[166:167], v54 offset:61952
    v_mfma_f32_16x16x32_bf16 v[140:143], v[188:191], a[52:55], v[140:143]
    ds_read_b128 a[60:63], v50 offset:32768
    ds_read_b64_tr_b16 v[168:169], v51 offset:55296
    s_waitcnt lgkmcnt(8)
    v_mfma_f32_32x32x16_bf16 v[72:87], v[152:155], a[56:59], v[72:87]
    s_add_u32 m0, s34, 49152
    s_add_u32 s33, s33, s91
    buffer_load_dwordx4 v14, s[48:51], s33 offen offset:0 lds
    ds_read_b64_tr_b16 v[170:171], v51 offset:55808
    ds_read_b64_tr_b16 v[172:173], v52 offset:55296
    s_waitcnt lgkmcnt(8)
    v_mfma_f32_32x32x16_bf16 v[88:103], v[156:159], a[56:59], v[88:103]
    ds_read_b64_tr_b16 v[174:175], v52 offset:55808
    ds_read_b64_tr_b16 v[176:177], v53 offset:63488
    s_waitcnt lgkmcnt(8)
    v_mfma_f32_32x32x16_bf16 v[104:119], a[56:59], v[160:163], v[104:119]
    buffer_load_dwordx4 v15, s[48:51], s33 offen offset:1024 lds
    ds_read_b64_tr_b16 v[178:179], v53 offset:64000
    ds_read_b64_tr_b16 v[180:181], v54 offset:63488
    s_waitcnt lgkmcnt(8)
    v_mfma_f32_32x32x16_bf16 v[120:135], a[56:59], v[164:167], v[120:135]
    ds_read_b64_tr_b16 v[182:183], v54 offset:64000
    v_mfma_f32_16x16x32_bf16 v[144:147], v[188:191], a[56:59], v[144:147]
    s_waitcnt lgkmcnt(6)
    v_mfma_f32_32x32x16_bf16 v[72:87], v[168:171], a[60:63], v[72:87]
    s_waitcnt vmcnt(7)
    s_barrier
    ds_read_b128 a[64:67], v33 offset:0
    ds_read_b64_tr_b16 v[152:153], v43 offset:16384
    ds_read_b64_tr_b16 v[154:155], v43 offset:16896
    ds_read_b64_tr_b16 v[156:157], v44 offset:16384
    s_waitcnt lgkmcnt(8)
    v_mfma_f32_32x32x16_bf16 v[88:103], v[172:175], a[60:63], v[88:103]
    ds_read_b64_tr_b16 v[158:159], v44 offset:16896
    ds_read_b64_tr_b16 v[160:161], v45 offset:24576
    ds_read_b64_tr_b16 v[162:163], v45 offset:25088
    ds_read_b64_tr_b16 v[164:165], v46 offset:24576
    s_waitcnt lgkmcnt(10)
    v_mfma_f32_32x32x16_bf16 v[104:119], a[60:63], v[176:179], v[104:119]
    s_add_u32 m0, s34, 57344
    s_add_u32 s33, s33, s30
    buffer_load_dwordx4 v14, s[52:55], s33 offen offset:0 lds
    ds_read_b64_tr_b16 v[166:167], v46 offset:25088
    ds_read_b128 v[184:187], v55 offset:512
    s_waitcnt lgkmcnt(10)
    v_mfma_f32_32x32x16_bf16 v[120:135], a[60:63], v[180:183], v[120:135]
    buffer_load_dwordx4 v15, s[52:55], s33 offen offset:1024 lds
    s_add_u32 s85, s85, 1
    s_and_b32 s85, s85, 7
    v_mfma_f32_16x16x32_bf16 v[148:151], v[188:191], a[60:63], v[148:151]
    ds_read_b128 a[68:71], v34 offset:0
    ds_read_b64_tr_b16 v[168:169], v43 offset:18432
    s_waitcnt lgkmcnt(9)
    v_mfma_f32_32x32x16_bf16 v[72:87], v[152:155], a[64:67], v[72:87]
    s_lshl_b32 s32, s85, 7
    s_add_u32 s32, s32, s90
    s_add_u32 m0, s31, 65536
    s_mul_i32 s33, s85, s3
    buffer_load_dwordx4 v9, s[40:43], s32 offen offset:0 lds
    ds_read_b64_tr_b16 v[170:171], v43 offset:18944
    ds_read_b64_tr_b16 v[172:173], v44 offset:18432
    s_waitcnt lgkmcnt(9)
    v_mfma_f32_32x32x16_bf16 v[88:103], v[156:159], a[64:67], v[88:103]
    ds_read_b64_tr_b16 v[174:175], v44 offset:18944
    ds_read_b64_tr_b16 v[176:177], v45 offset:26624
    s_waitcnt lgkmcnt(9)
    v_mfma_f32_32x32x16_bf16 v[104:119], a[64:67], v[160:163], v[104:119]
    buffer_load_dwordx4 v10, s[40:43], s32 offen offset:1024 lds
    ds_read_b64_tr_b16 v[178:179], v45 offset:27136
    ds_read_b64_tr_b16 v[180:181], v46 offset:26624
    s_waitcnt lgkmcnt(9)
    v_mfma_f32_32x32x16_bf16 v[120:135], a[64:67], v[164:167], v[120:135]
    ds_read_b64_tr_b16 v[182:183], v46 offset:27136
    s_waitcnt lgkmcnt(9)
    v_mfma_f32_16x16x32_bf16 v[136:139], v[184:187], a[64:67], v[136:139]
    ds_read_b128 a[72:75], v35 offset:0
    ds_read_b64_tr_b16 v[152:153], v43 offset:20480
    s_waitcnt lgkmcnt(8)
    v_mfma_f32_32x32x16_bf16 v[72:87], v[168:171], a[68:71], v[72:87]
    buffer_load_dwordx4 v11, s[40:43], s32 offen offset:2048 lds
    ds_read_b64_tr_b16 v[154:155], v43 offset:20992
    ds_read_b64_tr_b16 v[156:157], v44 offset:20480
    s_waitcnt lgkmcnt(8)
    v_mfma_f32_32x32x16_bf16 v[88:103], v[172:175], a[68:71], v[88:103]
    ds_read_b64_tr_b16 v[158:159], v44 offset:20992
    ds_read_b64_tr_b16 v[160:161], v45 offset:28672
    s_waitcnt lgkmcnt(8)
    v_mfma_f32_32x32x16_bf16 v[104:119], a[68:71], v[176:179], v[104:119]
    buffer_load_dwordx4 v12, s[40:43], s32 offen offset:3072 lds
    ds_read_b64_tr_b16 v[162:163], v45 offset:29184
    ds_read_b64_tr_b16 v[164:165], v46 offset:28672
    s_waitcnt lgkmcnt(8)
    v_mfma_f32_32x32x16_bf16 v[120:135], a[68:71], v[180:183], v[120:135]
    ds_read_b64_tr_b16 v[166:167], v46 offset:29184
    v_mfma_f32_16x16x32_bf16 v[140:143], v[184:187], a[68:71], v[140:143]
    ds_read_b128 a[76:79], v36 offset:0
    ds_read_b64_tr_b16 v[168:169], v43 offset:22528
    s_waitcnt lgkmcnt(8)
    v_mfma_f32_32x32x16_bf16 v[72:87], v[152:155], a[72:75], v[72:87]
    s_add_u32 m0, s34, 81920
    s_add_u32 s33, s33, s91
    buffer_load_dwordx4 v14, s[48:51], s33 offen offset:0 lds
    ds_read_b64_tr_b16 v[170:171], v43 offset:23040
    ds_read_b64_tr_b16 v[172:173], v44 offset:22528
    s_waitcnt lgkmcnt(8)
    v_mfma_f32_32x32x16_bf16 v[88:103], v[156:159], a[72:75], v[88:103]
    ds_read_b64_tr_b16 v[174:175], v44 offset:23040
    ds_read_b64_tr_b16 v[176:177], v45 offset:30720
    s_waitcnt lgkmcnt(8)
    v_mfma_f32_32x32x16_bf16 v[104:119], a[72:75], v[160:163], v[104:119]
    buffer_load_dwordx4 v15, s[48:51], s33 offen offset:1024 lds
    ds_read_b64_tr_b16 v[178:179], v45 offset:31232
    ds_read_b64_tr_b16 v[180:181], v46 offset:30720
    s_waitcnt lgkmcnt(8)
    v_mfma_f32_32x32x16_bf16 v[120:135], a[72:75], v[164:167], v[120:135]
    ds_read_b64_tr_b16 v[182:183], v46 offset:31232
    v_mfma_f32_16x16x32_bf16 v[144:147], v[184:187], a[72:75], v[144:147]
    s_waitcnt lgkmcnt(6)
    v_mfma_f32_32x32x16_bf16 v[72:87], v[168:171], a[76:79], v[72:87]
    s_waitcnt vmcnt(6)
    s_barrier
    ds_read_b128 a[80:83], v33 offset:32768
    ds_read_b64_tr_b16 v[152:153], v43 offset:49152
    ds_read_b64_tr_b16 v[154:155], v43 offset:49664
    ds_read_b64_tr_b16 v[156:157], v44 offset:49152
    s_waitcnt lgkmcnt(8)
    v_mfma_f32_32x32x16_bf16 v[88:103], v[172:175], a[76:79], v[88:103]
    ds_read_b64_tr_b16 v[158:159], v44 offset:49664
    ds_read_b64_tr_b16 v[160:161], v45 offset:57344
    ds_read_b64_tr_b16 v[162:163], v45 offset:57856
    ds_read_b64_tr_b16 v[164:165], v46 offset:57344
    s_waitcnt lgkmcnt(10)
    v_mfma_f32_32x32x16_bf16 v[104:119], a[76:79], v[176:179], v[104:119]
    s_add_u32 m0, s34, 90112
    s_add_u32 s33, s33, s30
    buffer_load_dwordx4 v14, s[52:55], s33 offen offset:0 lds
    ds_read_b64_tr_b16 v[166:167], v46 offset:57856
    ds_read_b128 v[188:191], v55 offset:640
    s_waitcnt lgkmcnt(10)
    v_mfma_f32_32x32x16_bf16 v[120:135], a[76:79], v[180:183], v[120:135]
    buffer_load_dwordx4 v15, s[52:55], s33 offen offset:1024 lds
    s_add_u32 s85, s85, 1
    s_and_b32 s85, s85, 7
    v_mfma_f32_16x16x32_bf16 v[148:151], v[184:187], a[76:79], v[148:151]
    ds_read_b128 a[84:87], v34 offset:32768
    ds_read_b64_tr_b16 v[168:169], v43 offset:51200
    s_waitcnt lgkmcnt(9)
    v_mfma_f32_32x32x16_bf16 v[72:87], v[152:155], a[80:83], v[72:87]
    s_lshl_b32 s32, s85, 7
    s_add_u32 s32, s32, s90
    s_add_u32 m0, s31, 98304
    s_mul_i32 s33, s85, s3
    buffer_load_dwordx4 v9, s[40:43], s32 offen offset:0 lds
    ds_read_b64_tr_b16 v[170:171], v43 offset:51712
    ds_read_b64_tr_b16 v[172:173], v44 offset:51200
    s_waitcnt lgkmcnt(9)
    v_mfma_f32_32x32x16_bf16 v[88:103], v[156:159], a[80:83], v[88:103]
    ds_read_b64_tr_b16 v[174:175], v44 offset:51712
    ds_read_b64_tr_b16 v[176:177], v45 offset:59392
    s_waitcnt lgkmcnt(9)
    v_mfma_f32_32x32x16_bf16 v[104:119], a[80:83], v[160:163], v[104:119]
    buffer_load_dwordx4 v10, s[40:43], s32 offen offset:1024 lds
    ds_read_b64_tr_b16 v[178:179], v45 offset:59904
    ds_read_b64_tr_b16 v[180:181], v46 offset:59392
    s_waitcnt lgkmcnt(9)
    v_mfma_f32_32x32x16_bf16 v[120:135], a[80:83], v[164:167], v[120:135]
    ds_read_b64_tr_b16 v[182:183], v46 offset:59904
    s_waitcnt lgkmcnt(9)
    v_mfma_f32_16x16x32_bf16 v[136:139], v[188:191], a[80:83], v[136:139]
    ds_read_b128 a[88:91], v35 offset:32768
    ds_read_b64_tr_b16 v[152:153], v43 offset:53248
    s_waitcnt lgkmcnt(8)
    v_mfma_f32_32x32x16_bf16 v[72:87], v[168:171], a[84:87], v[72:87]
    buffer_load_dwordx4 v11, s[40:43], s32 offen offset:2048 lds
    ds_read_b64_tr_b16 v[154:155], v43 offset:53760
    ds_read_b64_tr_b16 v[156:157], v44 offset:53248
    s_waitcnt lgkmcnt(8)
    v_mfma_f32_32x32x16_bf16 v[88:103], v[172:175], a[84:87], v[88:103]
    ds_read_b64_tr_b16 v[158:159], v44 offset:53760
    ds_read_b64_tr_b16 v[160:161], v45 offset:61440
    s_waitcnt lgkmcnt(8)
    v_mfma_f32_32x32x16_bf16 v[104:119], a[84:87], v[176:179], v[104:119]
    buffer_load_dwordx4 v12, s[40:43], s32 offen offset:3072 lds
    ds_read_b64_tr_b16 v[162:163], v45 offset:61952
    ds_read_b64_tr_b16 v[164:165], v46 offset:61440
    s_waitcnt lgkmcnt(8)
    v_mfma_f32_32x32x16_bf16 v[120:135], a[84:87], v[180:183], v[120:135]
    ds_read_b64_tr_b16 v[166:167], v46 offset:61952
    v_mfma_f32_16x16x32_bf16 v[140:143], v[188:191], a[84:87], v[140:143]
    ds_read_b128 a[92:95], v36 offset:32768
    ds_read_b64_tr_b16 v[168:169], v43 offset:55296
    s_waitcnt lgkmcnt(8)
    v_mfma_f32_32x32x16_bf16 v[72:87], v[152:155], a[88:91], v[72:87]
    s_add_u32 m0, s34, 114688
    s_add_u32 s33, s33, s91
    buffer_load_dwordx4 v14, s[48:51], s33 offen offset:0 lds
    ds_read_b64_tr_b16 v[170:171], v43 offset:55808
    ds_read_b64_tr_b16 v[172:173], v44 offset:55296
    s_waitcnt lgkmcnt(8)
    v_mfma_f32_32x32x16_bf16 v[88:103], v[156:159], a[88:91], v[88:103]
    ds_read_b64_tr_b16 v[174:175], v44 offset:55808
    ds_read_b64_tr_b16 v[176:177], v45 offset:63488
    s_waitcnt lgkmcnt(8)
    v_mfma_f32_32x32x16_bf16 v[104:119], a[88:91], v[160:163], v[104:119]
    buffer_load_dwordx4 v15, s[48:51], s33 offen offset:1024 lds
    ds_read_b64_tr_b16 v[178:179], v45 offset:64000
    ds_read_b64_tr_b16 v[180:181], v46 offset:63488
    s_waitcnt lgkmcnt(8)
    v_mfma_f32_32x32x16_bf16 v[120:135], a[88:91], v[164:167], v[120:135]
    ds_read_b64_tr_b16 v[182:183], v46 offset:64000
    v_mfma_f32_16x16x32_bf16 v[144:147], v[188:191], a[88:91], v[144:147]
    s_waitcnt lgkmcnt(6)
    v_mfma_f32_32x32x16_bf16 v[72:87], v[168:171], a[92:95], v[72:87]
    s_waitcnt vmcnt(6)
    s_barrier
    ds_read_b128 a[96:99], v47 offset:0
    ds_read_b64_tr_b16 v[152:153], v51 offset:16384
    ds_read_b64_tr_b16 v[154:155], v51 offset:16896
    ds_read_b64_tr_b16 v[156:157], v52 offset:16384
    s_waitcnt lgkmcnt(8)
    v_mfma_f32_32x32x16_bf16 v[88:103], v[172:175], a[92:95], v[88:103]
    ds_read_b64_tr_b16 v[158:159], v52 offset:16896
    ds_read_b64_tr_b16 v[160:161], v53 offset:24576
    ds_read_b64_tr_b16 v[162:163], v53 offset:25088
    ds_read_b64_tr_b16 v[164:165], v54 offset:24576
    s_waitcnt lgkmcnt(10)
    v_mfma_f32_32x32x16_bf16 v[104:119], a[92:95], v[176:179], v[104:119]
    s_add_u32 m0, s34, 122880
    s_add_u32 s33, s33, s30
    buffer_load_dwordx4 v14, s[52:55], s33 offen offset:0 lds
    ds_read_b64_tr_b16 v[166:167], v54 offset:25088
    ds_read_b128 v[184:187], v55 offset:768
    s_waitcnt lgkmcnt(10)
    v_mfma_f32_32x32x16_bf16 v[120:135], a[92:95], v[180:183], v[120:135]
    buffer_load_dwordx4 v15, s[52:55], s33 offen offset:1024 lds
    s_add_u32 s85, s85, 1
    s_and_b32 s85, s85, 7
    v_mfma_f32_16x16x32_bf16 v[148:151], v[188:191], a[92:95], v[148:151]
    ds_read_b128 a[100:103], v48 offset:0
    ds_read_b64_tr_b16 v[168:169], v51 offset:18432
    s_waitcnt lgkmcnt(9)
    v_mfma_f32_32x32x16_bf16 v[72:87], v[152:155], a[96:99], v[72:87]
    s_lshr_b32 s33, s31, 2
    s_add_u32 m0, s33, 0
    s_mul_i32 s32, s85, 196608
    s_add_u32 s85, s85, 1
    buffer_load_dwordx4 v23, s[44:47], s32 offen lds
    s_and_b32 s85, s85, 7
    ds_read_b64_tr_b16 v[170:171], v51 offset:18944
    ds_read_b64_tr_b16 v[172:173], v52 offset:18432
    s_waitcnt lgkmcnt(9)
    v_mfma_f32_32x32x16_bf16 v[88:103], v[156:159], a[96:99], v[88:103]
    ds_read_b64_tr_b16 v[174:175], v52 offset:18944
    ds_read_b64_tr_b16 v[176:177], v53 offset:26624
    s_waitcnt lgkmcnt(9)
    v_mfma_f32_32x32x16_bf16 v[104:119], a[96:99], v[160:163], v[104:119]
    s_lshr_b32 s33, s31, 2
    s_add_u32 m0, s33, 4096
    s_mul_i32 s32, s85, 196608
    s_add_u32 s85, s85, 1
    buffer_load_dwordx4 v23, s[44:47], s32 offen lds
    s_and_b32 s85, s85, 7
    ds_read_b64_tr_b16 v[178:179], v53 offset:27136
    ds_read_b64_tr_b16 v[180:181], v54 offset:26624
    s_waitcnt lgkmcnt(9)
    v_mfma_f32_32x32x16_bf16 v[120:135], a[96:99], v[164:167], v[120:135]
    ds_read_b64_tr_b16 v[182:183], v54 offset:27136
    s_waitcnt lgkmcnt(9)
    v_mfma_f32_16x16x32_bf16 v[136:139], v[184:187], a[96:99], v[136:139]
    ds_read_b128 a[104:107], v49 offset:0
    ds_read_b64_tr_b16 v[152:153], v51 offset:20480
    s_waitcnt lgkmcnt(8)
    v_mfma_f32_32x32x16_bf16 v[72:87], v[168:171], a[100:103], v[72:87]
    s_lshr_b32 s33, s31, 2
    s_add_u32 m0, s33, 8192
    s_mul_i32 s32, s85, 196608
    s_add_u32 s85, s85, 1
    buffer_load_dwordx4 v23, s[44:47], s32 offen lds
    s_and_b32 s85, s85, 7
    ds_read_b64_tr_b16 v[154:155], v51 offset:20992
    ds_read_b64_tr_b16 v[156:157], v52 offset:20480
    s_waitcnt lgkmcnt(8)
    v_mfma_f32_32x32x16_bf16 v[88:103], v[172:175], a[100:103], v[88:103]
    ds_read_b64_tr_b16 v[158:159], v52 offset:20992
    ds_read_b64_tr_b16 v[160:161], v53 offset:28672
    s_waitcnt lgkmcnt(8)
    v_mfma_f32_32x32x16_bf16 v[104:119], a[100:103], v[176:179], v[104:119]
    s_lshr_b32 s33, s31, 2
    s_add_u32 m0, s33, 12288
    s_mul_i32 s32, s85, 196608
    s_add_u32 s85, s85, 1
    buffer_load_dwordx4 v23, s[44:47], s32 offen lds
    s_and_b32 s85, s85, 7
    ds_read_b64_tr_b16 v[162:163], v53 offset:29184
    ds_read_b64_tr_b16 v[164:165], v54 offset:28672
    s_waitcnt lgkmcnt(8)
    v_mfma_f32_32x32x16_bf16 v[120:135], a[100:103], v[180:183], v[120:135]
    ds_read_b64_tr_b16 v[166:167], v54 offset:29184
    v_mfma_f32_16x16x32_bf16 v[140:143], v[184:187], a[100:103], v[140:143]
    ds_read_b128 a[108:111], v50 offset:0
    ds_read_b64_tr_b16 v[168:169], v51 offset:22528
    s_waitcnt lgkmcnt(8)
    v_mfma_f32_32x32x16_bf16 v[72:87], v[152:155], a[104:107], v[72:87]
    s_lshr_b32 s33, s31, 2
    s_add_u32 m0, s33, 16384
    s_mul_i32 s32, s85, 196608
    s_add_u32 s85, s85, 1
    buffer_load_dwordx4 v23, s[44:47], s32 offen lds
    s_and_b32 s85, s85, 7
    ds_read_b64_tr_b16 v[170:171], v51 offset:23040
    ds_read_b64_tr_b16 v[172:173], v52 offset:22528
    s_waitcnt lgkmcnt(8)
    v_mfma_f32_32x32x16_bf16 v[88:103], v[156:159], a[104:107], v[88:103]
    ds_read_b64_tr_b16 v[174:175], v52 offset:23040
    ds_read_b64_tr_b16 v[176:177], v53 offset:30720
    s_waitcnt lgkmcnt(8)
    v_mfma_f32_32x32x16_bf16 v[104:119], a[104:107], v[160:163], v[104:119]
    s_lshr_b32 s33, s31, 2
    s_add_u32 m0, s33, 20480
    s_mul_i32 s32, s85, 196608
    s_add_u32 s85, s85, 1
    buffer_load_dwordx4 v23, s[44:47], s32 offen lds
    s_and_b32 s85, s85, 7
    ds_read_b64_tr_b16 v[178:179], v53 offset:31232
    ds_read_b64_tr_b16 v[180:181], v54 offset:30720
    s_waitcnt lgkmcnt(8)
    v_mfma_f32_32x32x16_bf16 v[120:135], a[104:107], v[164:167], v[120:135]
    ds_read_b64_tr_b16 v[182:183], v54 offset:31232
    v_mfma_f32_16x16x32_bf16 v[144:147], v[184:187], a[104:107], v[144:147]
    s_waitcnt lgkmcnt(6)
    v_mfma_f32_32x32x16_bf16 v[72:87], v[168:171], a[108:111], v[72:87]
    s_waitcnt vmcnt(6)
    s_barrier
    buffer_store_dword v17, v63, s[56:59], s26 offen offset:1024 sc1
    ds_read_b128 a[112:115], v47 offset:32768
    ds_read_b64_tr_b16 v[152:153], v51 offset:49152
    ds_read_b64_tr_b16 v[154:155], v51 offset:49664
    ds_read_b64_tr_b16 v[156:157], v52 offset:49152
    s_waitcnt lgkmcnt(8)
    v_mfma_f32_32x32x16_bf16 v[88:103], v[172:175], a[108:111], v[88:103]
    ds_read_b64_tr_b16 v[158:159], v52 offset:49664
    ds_read_b64_tr_b16 v[160:161], v53 offset:57344
    ds_read_b64_tr_b16 v[162:163], v53 offset:57856
    ds_read_b64_tr_b16 v[164:165], v54 offset:57344
    s_waitcnt lgkmcnt(10)
    v_mfma_f32_32x32x16_bf16 v[104:119], a[108:111], v[176:179], v[104:119]
    s_lshr_b32 s33, s31, 2
    s_add_u32 m0, s33, 24576
    s_mul_i32 s32, s85, 196608
    s_add_u32 s85, s85, 1
    buffer_load_dwordx4 v23, s[44:47], s32 offen lds
    s_and_b32 s85, s85, 7
    ds_read_b64_tr_b16 v[166:167], v54 offset:57856
    ds_read_b128 v[188:191], v55 offset:896
    s_waitcnt lgkmcnt(10)
    v_mfma_f32_32x32x16_bf16 v[120:135], a[108:111], v[180:183], v[120:135]
    s_lshr_b32 s33, s31, 2
    s_add_u32 m0, s33, 28672
    s_mul_i32 s32, s85, 196608
    s_add_u32 s85, s85, 1
    buffer_load_dwordx4 v23, s[44:47], s32 offen lds
    s_and_b32 s85, s85, 7
    v_mfma_f32_16x16x32_bf16 v[148:151], v[184:187], a[108:111], v[148:151]
    ds_read_b128 a[116:119], v48 offset:32768
    ds_read_b64_tr_b16 v[168:169], v51 offset:51200
    s_waitcnt lgkmcnt(9)
    v_mfma_f32_32x32x16_bf16 v[72:87], v[152:155], a[112:115], v[72:87]
    s_mul_i32 s33, s80, 8192
    s_add_u32 m0, s33, 32768
    s_xor_b32 s32, s35, 0
    s_lshl_b32 s32, s32, 7
    s_add_u32 s32, s32, s36
    buffer_load_dwordx4 v3, s[64:67], s32 offen offset:0 lds
    ds_read_b64_tr_b16 v[170:171], v51 offset:51712
    ds_read_b64_tr_b16 v[172:173], v52 offset:51200
    s_waitcnt lgkmcnt(9)
    v_mfma_f32_32x32x16_bf16 v[88:103], v[156:159], a[112:115], v[88:103]
    ds_read_b64_tr_b16 v[174:175], v52 offset:51712
    ds_read_b64_tr_b16 v[176:177], v53 offset:59392
    s_waitcnt lgkmcnt(9)
    v_mfma_f32_32x32x16_bf16 v[104:119], a[112:115], v[160:163], v[104:119]
    s_add_u32 s32, s32, 7168
    buffer_load_dwordx4 v13, s[64:67], s32 offen offset:1024 lds
    ds_read_b64_tr_b16 v[178:179], v53 offset:59904
    ds_read_b64_tr_b16 v[180:181], v54 offset:59392
    s_waitcnt lgkmcnt(9)
    v_mfma_f32_32x32x16_bf16 v[120:135], a[112:115], v[164:167], v[120:135]
    ds_read_b64_tr_b16 v[182:183], v54 offset:59904
    s_waitcnt lgkmcnt(9)
    v_mfma_f32_16x16x32_bf16 v[136:139], v[188:191], a[112:115], v[136:139]
    ds_read_b128 a[120:123], v49 offset:32768
    ds_read_b64_tr_b16 v[152:153], v51 offset:53248
    s_waitcnt lgkmcnt(8)
    v_mfma_f32_32x32x16_bf16 v[72:87], v[168:171], a[116:119], v[72:87]
    s_add_u32 s32, s32, 7168
    buffer_load_dwordx4 v3, s[64:67], s32 offen offset:2048 lds
    ds_read_b64_tr_b16 v[154:155], v51 offset:53760
    ds_read_b64_tr_b16 v[156:157], v52 offset:53248
    s_waitcnt lgkmcnt(8)
    v_mfma_f32_32x32x16_bf16 v[88:103], v[172:175], a[116:119], v[88:103]
    ds_read_b64_tr_b16 v[158:159], v52 offset:53760
    ds_read_b64_tr_b16 v[160:161], v53 offset:61440
    s_waitcnt lgkmcnt(8)
    v_mfma_f32_32x32x16_bf16 v[104:119], a[116:119], v[176:179], v[104:119]
    s_add_u32 s32, s32, 7168
    buffer_load_dwordx4 v13, s[64:67], s32 offen offset:3072 lds
    ds_read_b64_tr_b16 v[162:163], v53 offset:61952
    ds_read_b64_tr_b16 v[164:165], v54 offset:61440
    s_waitcnt lgkmcnt(8)
    v_mfma_f32_32x32x16_bf16 v[120:135], a[116:119], v[180:183], v[120:135]
    ds_read_b64_tr_b16 v[166:167], v54 offset:61952
    v_mfma_f32_16x16x32_bf16 v[140:143], v[188:191], a[116:119], v[140:143]
    ds_read_b128 a[124:127], v50 offset:32768
    ds_read_b64_tr_b16 v[168:169], v51 offset:55296
    s_waitcnt lgkmcnt(8)
    v_mfma_f32_32x32x16_bf16 v[72:87], v[152:155], a[120:123], v[72:87]
    s_add_u32 m0, s33, 36864
    s_add_u32 s32, s32, 11264
    buffer_load_dwordx4 v3, s[64:67], s32 offen offset:0 lds
    ds_read_b64_tr_b16 v[170:171], v51 offset:55808
    ds_read_b64_tr_b16 v[172:173], v52 offset:55296
    s_waitcnt lgkmcnt(8)
    v_mfma_f32_32x32x16_bf16 v[88:103], v[156:159], a[120:123], v[88:103]
    ds_read_b64_tr_b16 v[174:175], v52 offset:55808
    ds_read_b64_tr_b16 v[176:177], v53 offset:63488
    s_waitcnt lgkmcnt(8)
    v_mfma_f32_32x32x16_bf16 v[104:119], a[120:123], v[160:163], v[104:119]
    s_add_u32 s32, s32, 7168
    buffer_load_dwordx4 v13, s[64:67], s32 offen offset:1024 lds
    ds_read_b64_tr_b16 v[178:179], v53 offset:64000
    ds_read_b64_tr_b16 v[180:181], v54 offset:63488
    s_waitcnt lgkmcnt(8)
    v_mfma_f32_32x32x16_bf16 v[120:135], a[120:123], v[164:167], v[120:135]
    ds_read_b64_tr_b16 v[182:183], v54 offset:64000
    v_mfma_f32_16x16x32_bf16 v[144:147], v[188:191], a[120:123], v[144:147]
    s_waitcnt lgkmcnt(6)
    v_mfma_f32_32x32x16_bf16 v[72:87], v[168:171], a[124:127], v[72:87]
    s_add_u32 s32, s32, 7168
    buffer_load_dwordx4 v3, s[64:67], s32 offen offset:2048 lds
    s_waitcnt lgkmcnt(4)
    v_mfma_f32_32x32x16_bf16 v[88:103], v[172:175], a[124:127], v[88:103]
    s_waitcnt lgkmcnt(2)
    v_mfma_f32_32x32x16_bf16 v[104:119], a[124:127], v[176:179], v[104:119]
    s_add_u32 s32, s32, 7168
    buffer_load_dwordx4 v13, s[64:67], s32 offen offset:3072 lds
    s_waitcnt lgkmcnt(0)
    v_mfma_f32_32x32x16_bf16 v[120:135], a[124:127], v[180:183], v[120:135]
    v_mfma_f32_16x16x32_bf16 v[148:151], v[188:191], a[124:127], v[148:151]
    s_nop 0
    v_cvt_pk_bf16_f32 v152, v72, v73
    v_cvt_pk_bf16_f32 v153, v74, v75
    v_cvt_pk_bf16_f32 v154, v76, v77
    v_cvt_pk_bf16_f32 v155, v78, v79
    v_cvt_pk_bf16_f32 v156, v80, v81
    v_cvt_pk_bf16_f32 v157, v82, v83
    v_cvt_pk_bf16_f32 v158, v84, v85
    v_cvt_pk_bf16_f32 v159, v86, v87
    v_cvt_pk_bf16_f32 v160, v88, v89
    v_cvt_pk_bf16_f32 v161, v90, v91
    v_cvt_pk_bf16_f32 v162, v92, v93
    v_cvt_pk_bf16_f32 v163, v94, v95
    v_cvt_pk_bf16_f32 v164, v96, v97
    v_cvt_pk_bf16_f32 v165, v98, v99
    v_cvt_pk_bf16_f32 v166, v100, v101
    v_cvt_pk_bf16_f32 v167, v102, v103
    v_mfma_f32_32x32x16_bf16 v[168:183], v[192:195], v[152:155], 0
    v_mfma_f32_32x32x16_bf16 v[208:223], v[196:199], v[156:159], 0
    v_mfma_f32_32x32x16_bf16 v[224:239], v[200:203], v[160:163], 0
    v_mfma_f32_32x32x16_bf16 v[240:255], v[204:207], v[164:167], 0
    s_mov_b32 s39, 4096
    buffer_load_dwordx4 v[24:27], v18, s[56:59], s39 offen sc1
    v_bfe_u32 v11, v5, 1, 2
    v_lshlrev_b32 v12, 1, v6
    v_xor_b32 v11, v11, v12
    v_lshlrev_b32 v11, 4, v11
    v_lshl_add_u32 v11, v5, 6, v11
    s_lshl_b32 s38, s80, 11
    s_add_u32 s38, s38, 65536
    v_add_u32 v4, s38, v11
    v_xor_b32 v9, 16, v4
    s_mul_i32 s38, s80, 4160
    s_add_u32 s38, s38, 98304
    v_add_u32 v10, s38, v18
    s_barrier
    v_cvt_pk_bf16_f32 v72, v104, v105
    v_cvt_pk_bf16_f32 v73, v106, v107
    v_cvt_pk_bf16_f32 v74, v108, v109
    v_cvt_pk_bf16_f32 v75, v110, v111
    v_cvt_pk_bf16_f32 v76, v112, v113
    v_cvt_pk_bf16_f32 v77, v114, v115
    v_cvt_pk_bf16_f32 v78, v116, v117
    v_cvt_pk_bf16_f32 v79, v118, v119
    v_cvt_pk_bf16_f32 v80, v120, v121
    v_cvt_pk_bf16_f32 v81, v122, v123
    v_cvt_pk_bf16_f32 v82, v124, v125
    v_cvt_pk_bf16_f32 v83, v126, v127
    v_cvt_pk_bf16_f32 v84, v128, v129
    v_cvt_pk_bf16_f32 v85, v130, v131
    v_cvt_pk_bf16_f32 v86, v132, v133
    v_cvt_pk_bf16_f32 v87, v134, v135
    ds_write_b128 v10, v[72:75] offset:0
    ds_write_b128 v10, v[76:79] offset:1040
    ds_write_b128 v10, v[80:83] offset:2080
    ds_write_b128 v10, v[84:87] offset:3120
    v_mov_b32 v44, 0x3f803f80
    v_mov_b32 v45, 0x3f803f80
    v_mov_b32 v46, 0x3f803f80
    v_mov_b32 v47, 0x3f803f80
    v_and_b32 v11, 3, v0
    v_mul_u32_u24 v11, 1040, v11
    s_add_u32 s38, s38, 1024
    v_add_u32 v11, s38, v11
    ds_write_b128 v11, v[44:47]
    v_max3_f32 v20, v168, v169, v170
    v_max3_f32 v21, v171, v172, v173
    v_max3_f32 v20, v20, v174, v175
    v_max3_f32 v21, v21, v176, v177
    v_max3_f32 v20, v20, v178, v179
    s_mul_i32 s33, s80, -8192
    s_add_u32 m0, s33, 147456
    s_xor_b32 s32, s35, 0
    s_lshl_b32 s32, s32, 7
    s_add_u32 s32, s32, s36
    buffer_load_dwordx4 v3, s[68:71], s32 offen offset:0 lds
    v_max3_f32 v21, v21, v180, v181
    v_max3_f32 v20, v20, v182, v183
    v_max_f32 v20, v20, v21
    v_mul_f32 v20, 3216550459, v20
    v_pk_fma_f32 v[168:169], v[168:169], s[96:97], v[20:21] op_sel_hi:[1,1,0]
    v_pk_fma_f32 v[170:171], v[170:171], s[96:97], v[20:21] op_sel_hi:[1,1,0]
    s_add_u32 s32, s32, 7168
    buffer_load_dwordx4 v13, s[68:71], s32 offen offset:1024 lds
    v_pk_fma_f32 v[172:173], v[172:173], s[96:97], v[20:21] op_sel_hi:[1,1,0]
    v_pk_fma_f32 v[174:175], v[174:175], s[96:97], v[20:21] op_sel_hi:[1,1,0]
    v_pk_fma_f32 v[176:177], v[176:177], s[96:97], v[20:21] op_sel_hi:[1,1,0]
    v_pk_fma_f32 v[178:179], v[178:179], s[96:97], v[20:21] op_sel_hi:[1,1,0]
    v_pk_fma_f32 v[180:181], v[180:181], s[96:97], v[20:21] op_sel_hi:[1,1,0]
    v_pk_fma_f32 v[182:183], v[182:183], s[96:97], v[20:21] op_sel_hi:[1,1,0]
    s_add_u32 s32, s32, 7168
    buffer_load_dwordx4 v3, s[68:71], s32 offen offset:2048 lds
    v_exp_f32 v168, v168
    v_exp_f32 v169, v169
    v_exp_f32 v170, v170
    v_exp_f32 v171, v171
    v_exp_f32 v172, v172
    v_exp_f32 v173, v173
    s_add_u32 s32, s32, 7168
    buffer_load_dwordx4 v13, s[68:71], s32 offen offset:3072 lds
    v_exp_f32 v174, v174
    v_exp_f32 v175, v175
    v_exp_f32 v176, v176
    v_exp_f32 v177, v177
    v_exp_f32 v178, v178
    v_exp_f32 v179, v179
    s_add_u32 m0, s33, 151552
    s_add_u32 s32, s32, 11264
    buffer_load_dwordx4 v3, s[68:71], s32 offen offset:0 lds
    v_exp_f32 v180, v180
    v_exp_f32 v181, v181
    v_exp_f32 v182, v182
    v_exp_f32 v183, v183
    v_pk_add_f32 v[22:23], v[168:169], v[170:171]
    v_pk_add_f32 v[20:21], v[172:173], v[174:175]
    s_add_u32 s32, s32, 7168
    buffer_load_dwordx4 v13, s[68:71], s32 offen offset:1024 lds
    v_pk_add_f32 v[22:23], v[22:23], v[176:177]
    v_pk_add_f32 v[20:21], v[20:21], v[178:179]
    v_pk_add_f32 v[22:23], v[22:23], v[180:181]
    v_pk_add_f32 v[20:21], v[20:21], v[182:183]
    v_pk_add_f32 v[22:23], v[22:23], v[20:21]
    v_add_f32 v22, v22, v23
    s_add_u32 s32, s32, 7168
    buffer_load_dwordx4 v3, s[68:71], s32 offen offset:2048 lds
    v_rcp_f32 v22, v22
    s_nop 0
    v_pk_mul_f32 v[168:169], v[168:169], v[22:23] op_sel_hi:[1,0]
    v_pk_mul_f32 v[170:171], v[170:171], v[22:23] op_sel_hi:[1,0]
    v_pk_mul_f32 v[172:173], v[172:173], v[22:23] op_sel_hi:[1,0]
    v_pk_mul_f32 v[174:175], v[174:175], v[22:23] op_sel_hi:[1,0]
    v_pk_mul_f32 v[176:177], v[176:177], v[22:23] op_sel_hi:[1,0]
    s_add_u32 s32, s32, 7168
    buffer_load_dwordx4 v13, s[68:71], s32 offen offset:3072 lds
    v_pk_mul_f32 v[178:179], v[178:179], v[22:23] op_sel_hi:[1,0]
    v_pk_mul_f32 v[180:181], v[180:181], v[22:23] op_sel_hi:[1,0]
    v_pk_mul_f32 v[182:183], v[182:183], v[22:23] op_sel_hi:[1,0]
    v_cvt_pk_bf16_f32 v72, v168, v169
    v_cvt_pk_bf16_f32 v73, v170, v171
    v_cvt_pk_bf16_f32 v74, v172, v173
    v_cvt_pk_bf16_f32 v75, v174, v175
    v_cvt_pk_bf16_f32 v76, v176, v177
    v_cvt_pk_bf16_f32 v77, v178, v179
    v_cvt_pk_bf16_f32 v78, v180, v181
    v_cvt_pk_bf16_f32 v79, v182, v183
    ds_write_b128 v4, v[72:75] offset:0
    ds_write_b128 v9, v[76:79] offset:0
    v_max3_f32 v20, v208, v209, v210
    v_max3_f32 v21, v211, v212, v213
    v_max3_f32 v20, v20, v214, v215
    v_max3_f32 v21, v21, v216, v217
    v_max3_f32 v20, v20, v218, v219
    v_max3_f32 v21, v21, v220, v221
    v_max3_f32 v20, v20, v222, v223
    v_max_f32 v20, v20, v21
    v_mul_f32 v20, 3216550459, v20
    v_pk_fma_f32 v[208:209], v[208:209], s[96:97], v[20:21] op_sel_hi:[1,1,0]
    v_pk_fma_f32 v[210:211], v[210:211], s[96:97], v[20:21] op_sel_hi:[1,1,0]
    v_pk_fma_f32 v[212:213], v[212:213], s[96:97], v[20:21] op_sel_hi:[1,1,0]
    v_pk_fma_f32 v[214:215], v[214:215], s[96:97], v[20:21] op_sel_hi:[1,1,0]
    v_pk_fma_f32 v[216:217], v[216:217], s[96:97], v[20:21] op_sel_hi:[1,1,0]
    v_pk_fma_f32 v[218:219], v[218:219], s[96:97], v[20:21] op_sel_hi:[1,1,0]
    v_pk_fma_f32 v[220:221], v[220:221], s[96:97], v[20:21] op_sel_hi:[1,1,0]
    v_pk_fma_f32 v[222:223], v[222:223], s[96:97], v[20:21] op_sel_hi:[1,1,0]
    v_exp_f32 v208, v208
    v_exp_f32 v209, v209
    v_exp_f32 v210, v210
    v_exp_f32 v211, v211
    v_exp_f32 v212, v212
    v_exp_f32 v213, v213
    v_exp_f32 v214, v214
    v_exp_f32 v215, v215
    v_exp_f32 v216, v216
    v_exp_f32 v217, v217
    v_exp_f32 v218, v218
    v_exp_f32 v219, v219
    v_exp_f32 v220, v220
    v_exp_f32 v221, v221
    v_exp_f32 v222, v222
    v_exp_f32 v223, v223
    v_pk_add_f32 v[22:23], v[208:209], v[210:211]
    v_pk_add_f32 v[20:21], v[212:213], v[214:215]
    v_pk_add_f32 v[22:23], v[22:23], v[216:217]
    v_pk_add_f32 v[20:21], v[20:21], v[218:219]
    v_pk_add_f32 v[22:23], v[22:23], v[220:221]
    v_pk_add_f32 v[20:21], v[20:21], v[222:223]
    v_pk_add_f32 v[22:23], v[22:23], v[20:21]
    v_add_f32 v22, v22, v23
    v_rcp_f32 v22, v22
    s_nop 0
    v_pk_mul_f32 v[208:209], v[208:209], v[22:23] op_sel_hi:[1,0]
    v_pk_mul_f32 v[210:211], v[210:211], v[22:23] op_sel_hi:[1,0]
    v_pk_mul_f32 v[212:213], v[212:213], v[22:23] op_sel_hi:[1,0]
    v_pk_mul_f32 v[214:215], v[214:215], v[22:23] op_sel_hi:[1,0]
    v_pk_mul_f32 v[216:217], v[216:217], v[22:23] op_sel_hi:[1,0]
    v_pk_mul_f32 v[218:219], v[218:219], v[22:23] op_sel_hi:[1,0]
    v_pk_mul_f32 v[220:221], v[220:221], v[22:23] op_sel_hi:[1,0]
    v_pk_mul_f32 v[222:223], v[222:223], v[22:23] op_sel_hi:[1,0]
    v_cvt_pk_bf16_f32 v80, v208, v209
    v_cvt_pk_bf16_f32 v81, v210, v211
    v_cvt_pk_bf16_f32 v82, v212, v213
    v_cvt_pk_bf16_f32 v83, v214, v215
    v_cvt_pk_bf16_f32 v84, v216, v217
    v_cvt_pk_bf16_f32 v85, v218, v219
    v_cvt_pk_bf16_f32 v86, v220, v221
    v_cvt_pk_bf16_f32 v87, v222, v223
    ds_write_b128 v4, v[80:83] offset:8192
    ds_write_b128 v9, v[84:87] offset:8192
    s_waitcnt vmcnt(9)
    s_mul_i32 s86, s80, 8192
    s_add_u32 s86, s86, 32768
    v_add_u32 v58, s86, v37
    v_xor_b32 v59, 32, v58
    v_xor_b32 v60, 64, v58
    v_xor_b32 v61, 96, v58
    ds_read_b128 a[128:131], v58 offset:0
    ds_read_b128 a[132:135], v58 offset:4096
    ds_read_b128 a[136:139], v59 offset:0
    ds_read_b128 a[140:143], v59 offset:4096
    ds_read_b128 a[144:147], v60 offset:0
    ds_read_b128 a[148:151], v60 offset:4096
    ds_read_b128 a[152:155], v61 offset:0
    ds_read_b128 a[156:159], v61 offset:4096
    v_max3_f32 v20, v224, v225, v226
    v_max3_f32 v21, v227, v228, v229
    v_max3_f32 v20, v20, v230, v231
    v_max3_f32 v21, v21, v232, v233
    v_max3_f32 v20, v20, v234, v235
    v_max3_f32 v21, v21, v236, v237
    v_max3_f32 v20, v20, v238, v239
    v_max_f32 v20, v20, v21
    v_mul_f32 v20, 3216550459, v20
    v_pk_fma_f32 v[224:225], v[224:225], s[96:97], v[20:21] op_sel_hi:[1,1,0]
    v_pk_fma_f32 v[226:227], v[226:227], s[96:97], v[20:21] op_sel_hi:[1,1,0]
    v_pk_fma_f32 v[228:229], v[228:229], s[96:97], v[20:21] op_sel_hi:[1,1,0]
    s_waitcnt lgkmcnt(0)
    v_pk_fma_f32 v[230:231], v[230:231], s[96:97], v[20:21] op_sel_hi:[1,1,0]
    s_mul_i32 s33, s80, 8192
    s_add_u32 m0, s33, 32768
    s_xor_b32 s32, s35, 1
    s_lshl_b32 s32, s32, 7
    s_add_u32 s32, s32, s36
    buffer_load_dwordx4 v3, s[64:67], s32 offen offset:0 lds
    v_pk_fma_f32 v[232:233], v[232:233], s[96:97], v[20:21] op_sel_hi:[1,1,0]
    v_pk_fma_f32 v[234:235], v[234:235], s[96:97], v[20:21] op_sel_hi:[1,1,0]
    v_pk_fma_f32 v[236:237], v[236:237], s[96:97], v[20:21] op_sel_hi:[1,1,0]
    v_pk_fma_f32 v[238:239], v[238:239], s[96:97], v[20:21] op_sel_hi:[1,1,0]
    v_exp_f32 v224, v224
    s_add_u32 s32, s32, 7168
    buffer_load_dwordx4 v13, s[64:67], s32 offen offset:1024 lds
    v_exp_f32 v225, v225
    v_exp_f32 v226, v226
    v_exp_f32 v227, v227
    v_exp_f32 v228, v228
    v_exp_f32 v229, v229
    s_add_u32 s32, s32, 7168
    buffer_load_dwordx4 v3, s[64:67], s32 offen offset:2048 lds
    v_exp_f32 v230, v230
    v_exp_f32 v231, v231
    v_exp_f32 v232, v232
    v_exp_f32 v233, v233
    v_exp_f32 v234, v234
    s_add_u32 s32, s32, 7168
    buffer_load_dwordx4 v13, s[64:67], s32 offen offset:3072 lds
    v_exp_f32 v235, v235
    v_exp_f32 v236, v236
    v_exp_f32 v237, v237
    v_exp_f32 v238, v238
    v_exp_f32 v239, v239
    s_add_u32 m0, s33, 36864
    s_add_u32 s32, s32, 11264
    buffer_load_dwordx4 v3, s[64:67], s32 offen offset:0 lds
    v_pk_add_f32 v[22:23], v[224:225], v[226:227]
    v_pk_add_f32 v[20:21], v[228:229], v[230:231]
    v_pk_add_f32 v[22:23], v[22:23], v[232:233]
    v_pk_add_f32 v[20:21], v[20:21], v[234:235]
    v_pk_add_f32 v[22:23], v[22:23], v[236:237]
    s_add_u32 s32, s32, 7168
    buffer_load_dwordx4 v13, s[64:67], s32 offen offset:1024 lds
    v_pk_add_f32 v[20:21], v[20:21], v[238:239]
    v_pk_add_f32 v[22:23], v[22:23], v[20:21]
    v_add_f32 v22, v22, v23
    v_rcp_f32 v22, v22
    s_nop 0
    v_pk_mul_f32 v[224:225], v[224:225], v[22:23] op_sel_hi:[1,0]
    s_add_u32 s32, s32, 7168
    buffer_load_dwordx4 v3, s[64:67], s32 offen offset:2048 lds
    v_pk_mul_f32 v[226:227], v[226:227], v[22:23] op_sel_hi:[1,0]
    v_pk_mul_f32 v[228:229], v[228:229], v[22:23] op_sel_hi:[1,0]
    v_pk_mul_f32 v[230:231], v[230:231], v[22:23] op_sel_hi:[1,0]
    v_pk_mul_f32 v[232:233], v[232:233], v[22:23] op_sel_hi:[1,0]
    v_pk_mul_f32 v[234:235], v[234:235], v[22:23] op_sel_hi:[1,0]
    s_add_u32 s32, s32, 7168
    buffer_load_dwordx4 v13, s[64:67], s32 offen offset:3072 lds
    v_pk_mul_f32 v[236:237], v[236:237], v[22:23] op_sel_hi:[1,0]
    v_pk_mul_f32 v[238:239], v[238:239], v[22:23] op_sel_hi:[1,0]
    v_cvt_pk_bf16_f32 v72, v224, v225
    v_cvt_pk_bf16_f32 v73, v226, v227
    v_cvt_pk_bf16_f32 v74, v228, v229
    v_cvt_pk_bf16_f32 v75, v230, v231
    v_cvt_pk_bf16_f32 v76, v232, v233
    v_cvt_pk_bf16_f32 v77, v234, v235
    v_cvt_pk_bf16_f32 v78, v236, v237
    v_cvt_pk_bf16_f32 v79, v238, v239
    ds_write_b128 v4, v[72:75] offset:16384
    ds_write_b128 v9, v[76:79] offset:16384
    v_max3_f32 v20, v240, v241, v242
    v_max3_f32 v21, v243, v244, v245
    v_max3_f32 v20, v20, v246, v247
    v_max3_f32 v21, v21, v248, v249
    v_max3_f32 v20, v20, v250, v251
    v_max3_f32 v21, v21, v252, v253
    v_max3_f32 v20, v20, v254, v255
    v_max_f32 v20, v20, v21
    v_mul_f32 v20, 3216550459, v20
    v_pk_fma_f32 v[240:241], v[240:241], s[96:97], v[20:21] op_sel_hi:[1,1,0]
    v_pk_fma_f32 v[242:243], v[242:243], s[96:97], v[20:21] op_sel_hi:[1,1,0]
    v_pk_fma_f32 v[244:245], v[244:245], s[96:97], v[20:21] op_sel_hi:[1,1,0]
    v_pk_fma_f32 v[246:247], v[246:247], s[96:97], v[20:21] op_sel_hi:[1,1,0]
    v_pk_fma_f32 v[248:249], v[248:249], s[96:97], v[20:21] op_sel_hi:[1,1,0]
    v_pk_fma_f32 v[250:251], v[250:251], s[96:97], v[20:21] op_sel_hi:[1,1,0]
    v_pk_fma_f32 v[252:253], v[252:253], s[96:97], v[20:21] op_sel_hi:[1,1,0]
    v_pk_fma_f32 v[254:255], v[254:255], s[96:97], v[20:21] op_sel_hi:[1,1,0]
    v_exp_f32 v240, v240
    v_exp_f32 v241, v241
    v_exp_f32 v242, v242
    v_exp_f32 v243, v243
    v_exp_f32 v244, v244
    v_exp_f32 v245, v245
    v_exp_f32 v246, v246
    v_exp_f32 v247, v247
    v_exp_f32 v248, v248
    v_exp_f32 v249, v249
    v_exp_f32 v250, v250
    v_exp_f32 v251, v251
    v_exp_f32 v252, v252
    v_exp_f32 v253, v253
    v_exp_f32 v254, v254
    v_exp_f32 v255, v255
    v_pk_add_f32 v[22:23], v[240:241], v[242:243]
    v_pk_add_f32 v[20:21], v[244:245], v[246:247]
    v_pk_add_f32 v[22:23], v[22:23], v[248:249]
    v_pk_add_f32 v[20:21], v[20:21], v[250:251]
    v_pk_add_f32 v[22:23], v[22:23], v[252:253]
    v_pk_add_f32 v[20:21], v[20:21], v[254:255]
    v_pk_add_f32 v[22:23], v[22:23], v[20:21]
    v_add_f32 v22, v22, v23
    v_rcp_f32 v22, v22
    s_nop 0
    v_pk_mul_f32 v[240:241], v[240:241], v[22:23] op_sel_hi:[1,0]
    v_pk_mul_f32 v[242:243], v[242:243], v[22:23] op_sel_hi:[1,0]
    v_pk_mul_f32 v[244:245], v[244:245], v[22:23] op_sel_hi:[1,0]
    v_pk_mul_f32 v[246:247], v[246:247], v[22:23] op_sel_hi:[1,0]
    v_pk_mul_f32 v[248:249], v[248:249], v[22:23] op_sel_hi:[1,0]
    v_pk_mul_f32 v[250:251], v[250:251], v[22:23] op_sel_hi:[1,0]
    v_pk_mul_f32 v[252:253], v[252:253], v[22:23] op_sel_hi:[1,0]
    v_pk_mul_f32 v[254:255], v[254:255], v[22:23] op_sel_hi:[1,0]
    v_cvt_pk_bf16_f32 v80, v240, v241
    v_cvt_pk_bf16_f32 v81, v242, v243
    v_cvt_pk_bf16_f32 v82, v244, v245
    v_cvt_pk_bf16_f32 v83, v246, v247
    v_cvt_pk_bf16_f32 v84, v248, v249
    v_cvt_pk_bf16_f32 v85, v250, v251
    v_cvt_pk_bf16_f32 v86, v252, v253
    v_cvt_pk_bf16_f32 v87, v254, v255
    ds_write_b128 v4, v[80:83] offset:24576
    ds_write_b128 v9, v[84:87] offset:24576
    v_and_b32 v11, 1, v7
    v_lshlrev_b32 v11, 5, v11
    v_lshl_add_u32 v11, v42, 3, v11
    v_lshrrev_b32 v12, 1, v40
    v_lshl_add_u32 v12, v6, 1, v12
    v_lshlrev_b32 v12, 4, v12
    v_xor_b32 v11, v11, v12
    v_lshl_add_u32 v12, v6, 2, v40
    v_lshl_add_u32 v11, v12, 6, v11
    s_lshl_b32 s38, s80, 13
    s_add_u32 s38, s38, 65536
    v_add_u32 v14, s38, v11
    s_and_b32 s39, s80, 1
    v_and_b32 v11, 1, v7
    v_cmp_eq_u32 s[98:99], s39, v11
    v_mov_b32 v12, 1024
    s_nop 0
    v_cndmask_b32 v15, v12, v18, s[98:99]
    s_lshr_b32 s38, s80, 1
    s_mul_i32 s38, s38, 2080
    s_add_u32 s38, s38, 98304
    v_add_u32 v15, s38, v15
    s_waitcnt lgkmcnt(0)
    s_barrier
    ds_read_b64_tr_b16 v[168:169], v14 offset:0
    ds_read_b64_tr_b16 v[170:171], v14 offset:512
    ds_read_b128 v[224:227], v15 offset:0
    ds_read_b64_tr_b16 v[172:173], v14 offset:1024
    ds_read_b64_tr_b16 v[174:175], v14 offset:1536
    ds_read_b128 v[228:231], v15 offset:1040
    ds_read_b64_tr_b16 v[176:177], v14 offset:2048
    ds_read_b64_tr_b16 v[178:179], v14 offset:2560
    ds_read_b128 v[232:235], v15 offset:4160
    ds_read_b64_tr_b16 v[180:181], v14 offset:3072
    ds_read_b64_tr_b16 v[182:183], v14 offset:3584
    ds_read_b128 v[236:239], v15 offset:5200
    ds_read_b64_tr_b16 v[208:209], v14 offset:4096
    ds_read_b64_tr_b16 v[210:211], v14 offset:4608
    ds_read_b128 v[240:243], v15 offset:8320
    ds_read_b64_tr_b16 v[212:213], v14 offset:5120
    ds_read_b64_tr_b16 v[214:215], v14 offset:5632
    ds_read_b128 v[244:247], v15 offset:9360
    ds_read_b64_tr_b16 v[216:217], v14 offset:6144
    ds_read_b64_tr_b16 v[218:219], v14 offset:6656
    ds_read_b128 v[248:251], v15 offset:12480
    ds_read_b64_tr_b16 v[220:221], v14 offset:7168
    ds_read_b64_tr_b16 v[222:223], v14 offset:7680
    ds_read_b128 v[252:255], v15 offset:13520
    s_waitcnt lgkmcnt(15)
    v_mfma_f32_32x32x16_bf16 v[152:167], v[168:171], v[224:227], 0
    v_add_f32 v136, v136, v141
    v_add_f32 v146, v146, v151
    v_mfma_f32_32x32x16_bf16 v[152:167], v[172:175], v[228:231], v[152:167]
    v_add_f32 v136, v136, v146
    v_cvt_pk_bf16_f32 v136, v136, v136
    v_mfma_f32_32x32x16_bf16 v[152:167], v[176:179], v[232:235], v[152:167]
    v_and_b32 v136, 0xffff0000, v136
    v_mul_f32 v136, 3216550459, v136
    s_waitcnt lgkmcnt(12)
    v_mfma_f32_32x32x16_bf16 v[152:167], v[180:183], v[236:239], v[152:167]
    v_exp_f32 v136, v136
    s_nop 0
    v_add_f32 v136, 1.0, v136
    s_waitcnt lgkmcnt(9)
    v_mfma_f32_32x32x16_bf16 v[152:167], v[208:211], v[240:243], v[152:167]
    v_rcp_f32 v136, v136
    s_nop 0
    v_cvt_pk_bf16_f32 v136, v136, v136
    s_waitcnt lgkmcnt(6)
    v_mfma_f32_32x32x16_bf16 v[152:167], v[212:215], v[244:247], v[152:167]
    v_and_b32 v16, 0xffff0000, v136
    v_sub_f32 v136, 1.0, v16
    s_waitcnt lgkmcnt(3)
    v_mfma_f32_32x32x16_bf16 v[152:167], v[216:219], v[248:251], v[152:167]
    v_cvt_pk_bf16_f32 v136, v136, v136
    v_and_b32 v19, 0xffff0000, v136
    s_waitcnt lgkmcnt(0)
    v_mfma_f32_32x32x16_bf16 v[152:167], v[220:223], v[252:255], v[152:167]
    buffer_store_dword v19, v31, s[56:59], s27 offen sc1
    ds_read_b64_tr_b16 v[44:45], v56 offset:0
    ds_read_b64_tr_b16 v[46:47], v56 offset:256
    ds_read_b64_tr_b16 v[48:49], v56 offset:1024
    ds_read_b64_tr_b16 v[50:51], v56 offset:1280
    ds_read_b64_tr_b16 v[52:53], v56 offset:2048
    ds_read_b64_tr_b16 v[54:55], v56 offset:2304
    s_nop 4
    v_cvt_pk_bf16_f32 v72, v152, v153
    v_cvt_pk_bf16_f32 v73, v154, v155
    v_cvt_pk_bf16_f32 v74, v156, v157
    v_cvt_pk_bf16_f32 v75, v158, v159
    v_cvt_pk_bf16_f32 v76, v160, v161
    v_cvt_pk_bf16_f32 v77, v162, v163
    v_cvt_pk_bf16_f32 v78, v164, v165
    v_cvt_pk_bf16_f32 v79, v166, v167
    buffer_store_dwordx4 v[72:75], v29, s[56:59], 0 offen sc1
    buffer_store_dwordx4 v[76:79], v30, s[56:59], 0 offen sc1
    s_barrier
    s_waitcnt lgkmcnt(4)
    v_mfma_f32_32x32x16_bf16 v[88:103], v[44:47], a[0:3], 0
    ds_read_b64_tr_b16 v[104:105], v56 offset:3072
    ds_read_b64_tr_b16 v[106:107], v56 offset:3328
    s_waitcnt vmcnt(11)
    s_mul_i32 s33, s80, 16384
    s_add_u32 m0, s33, 65536
    s_xor_b32 s32, s35, 0
    s_lshl_b32 s32, s32, 16
    s_add_u32 s32, s32, s37
    buffer_load_dwordx4 v57, s[60:63], s32 offen offset:0 lds
    s_waitcnt lgkmcnt(4)
    v_mfma_f32_32x32x16_bf16 v[88:103], v[48:51], a[4:7], v[88:103]
    ds_read_b64_tr_b16 v[44:45], v56 offset:4096
    ds_read_b64_tr_b16 v[46:47], v56 offset:4352
    s_mul_i32 s86, s80, -8192
    s_lshl_b32 s39, s82, 2
    s_lshr_b32 s38, s80, 1
    s_add_u32 s39, s39, s38
    s_add_u32 s39, s39, 0
    s_lshl_b32 s88, s39, 10
    s_waitcnt lgkmcnt(4)
    v_mfma_f32_32x32x16_bf16 v[88:103], v[52:55], a[8:11], v[88:103]
    ds_read_b64_tr_b16 v[48:49], v56 offset:5120
    ds_read_b64_tr_b16 v[50:51], v56 offset:5376
    s_add_u32 s86, s86, 147456
    s_add_u32 s32, s32, 7168
    buffer_load_dwordx4 v57, s[60:63], s32 offen offset:1024 lds
    s_add_u32 s88, s88, 589824
    s_lshl_b32 s87, s39, 14
    s_waitcnt lgkmcnt(4)
    v_mfma_f32_32x32x16_bf16 v[88:103], v[104:107], a[12:15], v[88:103]
    ds_read_b64_tr_b16 v[52:53], v56 offset:6144
    ds_read_b64_tr_b16 v[54:55], v56 offset:6400
    v_add_u32 v58, s86, v37
    s_and_b32 s39, s80, 1
    s_lshl_b32 s39, s39, 9
    s_add_u32 s87, s87, s39
    s_add_u32 s87, s87, 65536
    s_waitcnt lgkmcnt(4)
    v_mfma_f32_32x32x16_bf16 v[88:103], v[44:47], a[16:19], v[88:103]
    ds_read_b64_tr_b16 v[104:105], v56 offset:7168
    ds_read_b64_tr_b16 v[106:107], v56 offset:7424
    v_xor_b32 v59, 32, v58
    s_add_u32 s32, s32, 7168
    buffer_load_dwordx4 v57, s[60:63], s32 offen offset:2048 lds
    s_waitcnt lgkmcnt(4)
    v_mfma_f32_32x32x16_bf16 v[88:103], v[48:51], a[20:23], v[88:103]
    ds_read_b64_tr_b16 v[44:45], v56 offset:8192
    ds_read_b64_tr_b16 v[46:47], v56 offset:8448
    v_xor_b32 v60, 64, v58
    v_lshlrev_b32 v11, 10, v6
    v_and_b32 v9, 1, v7
    s_waitcnt lgkmcnt(4)
    v_mfma_f32_32x32x16_bf16 v[88:103], v[52:55], a[24:27], v[88:103]
    ds_read_b64_tr_b16 v[48:49], v56 offset:9216
    ds_read_b64_tr_b16 v[50:51], v56 offset:9472
    v_xor_b32 v61, 96, v58
    s_add_u32 s32, s32, 7168
    buffer_load_dwordx4 v57, s[60:63], s32 offen offset:3072 lds
    s_waitcnt lgkmcnt(4)
    v_mfma_f32_32x32x16_bf16 v[88:103], v[104:107], a[28:31], v[88:103]
    ds_read_b64_tr_b16 v[52:53], v56 offset:10240
    ds_read_b64_tr_b16 v[54:55], v56 offset:10496
    ds_read_b128 a[160:163], v58 offset:0
    v_lshl_add_u32 v11, v9, 8, v11
    v_lshl_add_u32 v11, v8, 4, v11
    s_waitcnt lgkmcnt(5)
    v_mfma_f32_32x32x16_bf16 v[88:103], v[44:47], a[32:35], v[88:103]
    ds_read_b64_tr_b16 v[104:105], v56 offset:11264
    ds_read_b64_tr_b16 v[106:107], v56 offset:11520
    ds_read_b128 a[164:167], v58 offset:4096
    s_add_u32 m0, s33, 69632
    s_add_u32 s32, s32, 11264
    buffer_load_dwordx4 v57, s[60:63], s32 offen offset:0 lds
    s_waitcnt lgkmcnt(6)
    v_mfma_f32_32x32x16_bf16 v[88:103], v[48:51], a[36:39], v[88:103]
    ds_read_b64_tr_b16 v[44:45], v56 offset:12288
    ds_read_b64_tr_b16 v[46:47], v56 offset:12544
    ds_read_b128 a[168:171], v59 offset:0
    v_add_u32 v11, s87, v11
    v_and_b32 v10, 7, v0
    s_waitcnt lgkmcnt(7)
    v_mfma_f32_32x32x16_bf16 v[88:103], v[52:55], a[40:43], v[88:103]
    ds_read_b64_tr_b16 v[48:49], v56 offset:13312
    ds_read_b64_tr_b16 v[50:51], v56 offset:13568
    ds_read_b128 a[172:175], v59 offset:4096
    s_add_u32 s32, s32, 7168
    buffer_load_dwordx4 v57, s[60:63], s32 offen offset:1024 lds
    s_waitcnt lgkmcnt(7)
    v_mfma_f32_32x32x16_bf16 v[88:103], v[104:107], a[44:47], v[88:103]
    ds_read_b64_tr_b16 v[52:53], v56 offset:14336
    ds_read_b64_tr_b16 v[54:55], v56 offset:14592
    ds_read_b128 a[176:179], v60 offset:0
    v_lshlrev_b32 v10, 7, v10
    v_lshl_add_u32 v10, v6, 6, v10
    s_waitcnt lgkmcnt(7)
    v_mfma_f32_32x32x16_bf16 v[88:103], v[44:47], a[48:51], v[88:103]
    ds_read_b64_tr_b16 v[104:105], v56 offset:15360
    ds_read_b64_tr_b16 v[106:107], v56 offset:15616
    ds_read_b128 a[180:183], v60 offset:4096
    s_add_u32 s32, s32, 7168
    buffer_load_dwordx4 v57, s[60:63], s32 offen offset:2048 lds
    s_waitcnt lgkmcnt(7)
    v_mfma_f32_32x32x16_bf16 v[88:103], v[48:51], a[52:55], v[88:103]
    ds_read_b64_tr_b16 v[44:45], v56 offset:16384
    ds_read_b64_tr_b16 v[46:47], v56 offset:16640
    ds_read_b128 a[184:187], v61 offset:0
    v_lshl_add_u32 v10, v9, 4, v10
    v_bfe_u32 v4, v0, 3, 1
    s_waitcnt lgkmcnt(7)
    v_mfma_f32_32x32x16_bf16 v[88:103], v[52:55], a[56:59], v[88:103]
    ds_read_b64_tr_b16 v[48:49], v56 offset:17408
    ds_read_b64_tr_b16 v[50:51], v56 offset:17664
    ds_read_b128 a[188:191], v61 offset:4096
    s_add_u32 s32, s32, 7168
    buffer_load_dwordx4 v57, s[60:63], s32 offen offset:3072 lds
    s_waitcnt lgkmcnt(7)
    v_mfma_f32_32x32x16_bf16 v[88:103], v[104:107], a[60:63], v[88:103]
    ds_read_b64_tr_b16 v[52:53], v56 offset:18432
    ds_read_b64_tr_b16 v[54:55], v56 offset:18688
    s_waitcnt lgkmcnt(0)
    v_lshl_add_u32 v10, v4, 5, v10
    v_add_u32 v10, s88, v10
    s_mul_i32 s38, s38, 1088
    s_add_u32 s38, s38, 159744
    v_mfma_f32_32x32x16_bf16 v[88:103], v[44:47], a[64:67], v[88:103]
    ds_read_b64_tr_b16 v[104:105], v56 offset:19456
    ds_read_b64_tr_b16 v[106:107], v56 offset:19712
    s_mul_i32 s33, s80, 16384
    s_add_u32 m0, s33, 73728
    s_xor_b32 s32, s35, 1
    s_lshl_b32 s32, s32, 7
    s_add_u32 s32, s32, s36
    buffer_load_dwordx4 v3, s[68:71], s32 offen offset:0 lds
    v_mfma_f32_32x32x16_bf16 v[88:103], v[48:51], a[68:71], v[88:103]
    ds_read_b64_tr_b16 v[44:45], v56 offset:20480
    ds_read_b64_tr_b16 v[46:47], v56 offset:20736
    s_add_u32 s39, s39, s38
    v_lshlrev_b32 v12, 8, v6
    v_lshl_add_u32 v12, v8, 4, v12
    v_mfma_f32_32x32x16_bf16 v[88:103], v[52:55], a[72:75], v[88:103]
    ds_read_b64_tr_b16 v[48:49], v56 offset:21504
    ds_read_b64_tr_b16 v[50:51], v56 offset:21760
    s_add_u32 s32, s32, 7168
    buffer_load_dwordx4 v13, s[68:71], s32 offen offset:1024 lds
    v_lshl_add_u32 v12, v9, 3, v12
    s_waitcnt lgkmcnt(4)
    v_mfma_f32_32x32x16_bf16 v[88:103], v[104:107], a[76:79], v[88:103]
    ds_read_b64_tr_b16 v[52:53], v56 offset:22528
    ds_read_b64_tr_b16 v[54:55], v56 offset:22784
    v_add_u32 v12, s39, v12
    v_lshlrev_b32 v4, 5, v4
    v_lshl_add_u32 v14, v7, 3, v4
    s_waitcnt lgkmcnt(4)
    v_mfma_f32_32x32x16_bf16 v[88:103], v[44:47], a[80:83], v[88:103]
    ds_read_b64_tr_b16 v[104:105], v56 offset:23552
    ds_read_b64_tr_b16 v[106:107], v56 offset:23808
    s_add_u32 s32, s32, 7168
    buffer_load_dwordx4 v3, s[68:71], s32 offen offset:2048 lds
    s_add_u32 s38, s38, 1024
    v_add_u32 v14, s38, v14
    s_waitcnt lgkmcnt(4)
    v_mfma_f32_32x32x16_bf16 v[88:103], v[48:51], a[84:87], v[88:103]
    ds_read_b64_tr_b16 v[44:45], v56 offset:24576
    ds_read_b64_tr_b16 v[46:47], v56 offset:24832
    v_lshlrev_b32 v4, 9, v6
    v_lshl_add_u32 v4, v5, 4, v4
    v_lshlrev_b32 v9, 5, v6
    s_waitcnt lgkmcnt(4)
    v_mfma_f32_32x32x16_bf16 v[88:103], v[52:55], a[88:91], v[88:103]
    ds_read_b64_tr_b16 v[48:49], v56 offset:25600
    ds_read_b64_tr_b16 v[50:51], v56 offset:25856
    s_add_u32 s32, s32, 7168
    buffer_load_dwordx4 v13, s[68:71], s32 offen offset:3072 lds
    v_add_u32 v9, 1024, v9
    s_waitcnt lgkmcnt(4)
    v_mfma_f32_32x32x16_bf16 v[88:103], v[104:107], a[92:95], v[88:103]
    ds_read_b64_tr_b16 v[52:53], v56 offset:26624
    ds_read_b64_tr_b16 v[54:55], v56 offset:26880
    v_cmp_gt_u32 vcc, 16, v5
    s_nop 1
    v_cndmask_b32 v15, v9, v4, vcc
    v_mov_b32 v4, 256
    s_waitcnt lgkmcnt(4)
    v_mfma_f32_32x32x16_bf16 v[88:103], v[44:47], a[96:99], v[88:103]
    ds_read_b64_tr_b16 v[104:105], v56 offset:27648
    ds_read_b64_tr_b16 v[106:107], v56 offset:27904
    s_add_u32 m0, s33, 77824
    s_add_u32 s32, s32, 11264
    buffer_load_dwordx4 v3, s[68:71], s32 offen offset:0 lds
    v_cndmask_b32 v4, 16, v4, vcc
    s_waitcnt lgkmcnt(4)
    v_mfma_f32_32x32x16_bf16 v[88:103], v[48:51], a[100:103], v[88:103]
    ds_read_b64_tr_b16 v[44:45], v56 offset:28672
    ds_read_b64_tr_b16 v[46:47], v56 offset:28928
    v_add_u32 v15, 159744, v15
    v_add_u32 v20, v15, v4
    s_waitcnt lgkmcnt(4)
    v_mfma_f32_32x32x16_bf16 v[88:103], v[52:55], a[104:107], v[88:103]
    ds_read_b64_tr_b16 v[48:49], v56 offset:29696
    ds_read_b64_tr_b16 v[50:51], v56 offset:29952
    s_add_u32 s32, s32, 7168
    buffer_load_dwordx4 v13, s[68:71], s32 offen offset:1024 lds
    s_waitcnt lgkmcnt(4)
    v_mfma_f32_32x32x16_bf16 v[88:103], v[104:107], a[108:111], v[88:103]
    ds_read_b64_tr_b16 v[52:53], v56 offset:30720
    ds_read_b64_tr_b16 v[54:55], v56 offset:30976
    s_waitcnt lgkmcnt(4)
    v_mfma_f32_32x32x16_bf16 v[88:103], v[44:47], a[112:115], v[88:103]
    ds_read_b64_tr_b16 v[104:105], v56 offset:31744
    ds_read_b64_tr_b16 v[106:107], v56 offset:32000
    s_add_u32 s32, s32, 7168
    buffer_load_dwordx4 v3, s[68:71], s32 offen offset:2048 lds
    s_waitcnt lgkmcnt(4)
    v_mfma_f32_32x32x16_bf16 v[88:103], v[48:51], a[116:119], v[88:103]
    s_waitcnt lgkmcnt(2)
    v_mfma_f32_32x32x16_bf16 v[88:103], v[52:55], a[120:123], v[88:103]
    s_add_u32 s32, s32, 7168
    buffer_load_dwordx4 v13, s[68:71], s32 offen offset:3072 lds
    s_waitcnt lgkmcnt(0)
    v_mfma_f32_32x32x16_bf16 v[88:103], v[104:107], a[124:127], v[88:103]
    s_nop 11
    v_cvt_pk_bf16_f32 v44, v88, v89
    v_cvt_pk_bf16_f32 v45, v90, v91
    v_cvt_pk_bf16_f32 v46, v92, v93
    v_cvt_pk_bf16_f32 v47, v94, v95
    v_cvt_pk_bf16_f32 v48, v96, v97
    v_cvt_pk_bf16_f32 v49, v98, v99
    v_cvt_pk_bf16_f32 v50, v100, v101
    v_cvt_pk_bf16_f32 v51, v102, v103
gm_ck1:
    v_cmp_ne_u64 vcc, s[0:1], v[24:25]
    v_cmp_ne_u64 s[98:99], s[0:1], v[26:27]
    s_nop 3
    s_or_b64 vcc, vcc, s[98:99]
    s_cbranch_scc1 gm_rt3
gm_ok2:
    buffer_load_dwordx4 v[92:95], v10, s[56:59], 0 offen sc1
    buffer_load_dwordx4 v[24:27], v11, s[56:59], 0 offen offset:0 sc1
    buffer_load_dwordx4 v[28:31], v11, s[56:59], 0 offen offset:2048 sc1
    s_mov_b32 s38, 4096
    buffer_load_dwordx4 v[52:55], v11, s[56:59], s38 offen offset:0 sc1
    buffer_load_dwordx4 v[72:75], v11, s[56:59], s38 offen offset:2048 sc1
    s_mov_b32 s38, 8192
    buffer_load_dwordx4 v[76:79], v11, s[56:59], s38 offen offset:0 sc1
    buffer_load_dwordx4 v[80:83], v11, s[56:59], s38 offen offset:2048 sc1
    s_mov_b32 s38, 12288
    buffer_load_dwordx4 v[84:87], v11, s[56:59], s38 offen offset:0 sc1
    buffer_load_dwordx4 v[88:91], v11, s[56:59], s38 offen offset:2048 sc1
    s_mov_b32 s39, 5120
    buffer_load_dwordx4 v[96:99], v18, s[56:59], s39 offen sc1
    v_mfma_f32_32x32x16_bf16 v[100:115], v[192:195], v[44:47], 0
    v_mfma_f32_32x32x16_bf16 v[116:131], v[196:199], v[48:51], 0
    s_nop 10
    v_max3_f32 v132, v100, v101, v102
    s_waitcnt vmcnt(29)
    v_max3_f32 v133, v103, v104, v105
    s_mul_i32 s86, s80, 8192
    v_max3_f32 v132, v132, v106, v107
    s_add_u32 s86, s86, 32768
    v_max3_f32 v133, v133, v108, v109
    v_add_u32 v58, s86, v37
    v_max3_f32 v132, v132, v110, v111
    v_xor_b32 v59, 32, v58
    v_max3_f32 v133, v133, v112, v113
    v_xor_b32 v60, 64, v58
    v_max3_f32 v132, v132, v114, v115
    v_xor_b32 v61, 96, v58
    v_max_f32 v132, v132, v133
    ds_read_b128 a[192:195], v58 offset:0
    v_mul_f32 v132, 3216550459, v132
    ds_read_b128 a[196:199], v58 offset:4096
    v_pk_fma_f32 v[100:101], v[100:101], s[96:97], v[132:133] op_sel_hi:[1,1,0]
    ds_read_b128 a[200:203], v59 offset:0
    v_pk_fma_f32 v[102:103], v[102:103], s[96:97], v[132:133] op_sel_hi:[1,1,0]
    ds_read_b128 a[204:207], v59 offset:4096
    v_pk_fma_f32 v[104:105], v[104:105], s[96:97], v[132:133] op_sel_hi:[1,1,0]
    ds_read_b128 a[208:211], v60 offset:0
    v_pk_fma_f32 v[106:107], v[106:107], s[96:97], v[132:133] op_sel_hi:[1,1,0]
    ds_read_b128 a[212:215], v60 offset:4096
    v_pk_fma_f32 v[108:109], v[108:109], s[96:97], v[132:133] op_sel_hi:[1,1,0]
    ds_read_b128 a[216:219], v61 offset:0
    v_pk_fma_f32 v[110:111], v[110:111], s[96:97], v[132:133] op_sel_hi:[1,1,0]
    ds_read_b128 a[220:223], v61 offset:4096
    v_pk_fma_f32 v[112:113], v[112:113], s[96:97], v[132:133] op_sel_hi:[1,1,0]
    v_pk_fma_f32 v[114:115], v[114:115], s[96:97], v[132:133] op_sel_hi:[1,1,0]
    v_exp_f32 v100, v100
    v_exp_f32 v101, v101
    v_exp_f32 v102, v102
    v_exp_f32 v103, v103
    v_exp_f32 v104, v104
    v_exp_f32 v105, v105
    v_exp_f32 v106, v106
    v_exp_f32 v107, v107
    v_exp_f32 v108, v108
    v_exp_f32 v109, v109
    v_exp_f32 v110, v110
    v_exp_f32 v111, v111
    v_exp_f32 v112, v112
    v_exp_f32 v113, v113
    s_waitcnt lgkmcnt(0)
    v_exp_f32 v114, v114
    s_mul_i32 s33, s80, 8192
    s_add_u32 m0, s33, 32768
    s_xor_b32 s32, s35, 1
    s_lshl_b32 s32, s32, 16
    s_add_u32 s32, s32, s37
    buffer_load_dwordx4 v57, s[60:63], s32 offen offset:0 lds
    v_exp_f32 v115, v115
    v_pk_add_f32 v[134:135], v[100:101], v[102:103]
    v_pk_add_f32 v[132:133], v[104:105], v[106:107]
    v_pk_add_f32 v[134:135], v[134:135], v[108:109]
    v_pk_add_f32 v[132:133], v[132:133], v[110:111]
    v_pk_add_f32 v[134:135], v[134:135], v[112:113]
    s_add_u32 s32, s32, 7168
    buffer_load_dwordx4 v57, s[60:63], s32 offen offset:1024 lds
    v_pk_add_f32 v[132:133], v[132:133], v[114:115]
    v_pk_add_f32 v[134:135], v[134:135], v[132:133]
    v_add_f32 v134, v134, v135
    v_rcp_f32 v134, v134
    s_nop 0
    v_pk_mul_f32 v[100:101], v[100:101], v[134:135] op_sel_hi:[1,0]
    v_pk_mul_f32 v[102:103], v[102:103], v[134:135] op_sel_hi:[1,0]
    s_add_u32 s32, s32, 7168
    buffer_load_dwordx4 v57, s[60:63], s32 offen offset:2048 lds
    v_pk_mul_f32 v[104:105], v[104:105], v[134:135] op_sel_hi:[1,0]
    v_pk_mul_f32 v[106:107], v[106:107], v[134:135] op_sel_hi:[1,0]
    v_pk_mul_f32 v[108:109], v[108:109], v[134:135] op_sel_hi:[1,0]
    v_pk_mul_f32 v[110:111], v[110:111], v[134:135] op_sel_hi:[1,0]
    v_pk_mul_f32 v[112:113], v[112:113], v[134:135] op_sel_hi:[1,0]
    v_pk_mul_f32 v[114:115], v[114:115], v[134:135] op_sel_hi:[1,0]
    s_add_u32 s32, s32, 7168
    buffer_load_dwordx4 v57, s[60:63], s32 offen offset:3072 lds
    v_cvt_pk_bf16_f32 v44, v100, v101
    v_cvt_pk_bf16_f32 v45, v102, v103
    v_cvt_pk_bf16_f32 v46, v104, v105
    v_cvt_pk_bf16_f32 v47, v106, v107
    v_cvt_pk_bf16_f32 v48, v108, v109
    v_cvt_pk_bf16_f32 v49, v110, v111
    s_add_u32 m0, s33, 36864
    s_add_u32 s32, s32, 11264
    buffer_load_dwordx4 v57, s[60:63], s32 offen offset:0 lds
    v_cvt_pk_bf16_f32 v50, v112, v113
    v_cvt_pk_bf16_f32 v51, v114, v115
    v_max3_f32 v132, v116, v117, v118
    v_max3_f32 v133, v119, v120, v121
    v_max3_f32 v132, v132, v122, v123
    v_max3_f32 v133, v133, v124, v125
    s_add_u32 s32, s32, 7168
    buffer_load_dwordx4 v57, s[60:63], s32 offen offset:1024 lds
    v_max3_f32 v132, v132, v126, v127
    v_max3_f32 v133, v133, v128, v129
    v_max3_f32 v132, v132, v130, v131
    v_max_f32 v132, v132, v133
    v_mul_f32 v132, 3216550459, v132
    v_pk_fma_f32 v[116:117], v[116:117], s[96:97], v[132:133] op_sel_hi:[1,1,0]
    s_add_u32 s32, s32, 7168
    buffer_load_dwordx4 v57, s[60:63], s32 offen offset:2048 lds
    v_pk_fma_f32 v[118:119], v[118:119], s[96:97], v[132:133] op_sel_hi:[1,1,0]
    v_pk_fma_f32 v[120:121], v[120:121], s[96:97], v[132:133] op_sel_hi:[1,1,0]
    v_pk_fma_f32 v[122:123], v[122:123], s[96:97], v[132:133] op_sel_hi:[1,1,0]
    v_pk_fma_f32 v[124:125], v[124:125], s[96:97], v[132:133] op_sel_hi:[1,1,0]
    v_pk_fma_f32 v[126:127], v[126:127], s[96:97], v[132:133] op_sel_hi:[1,1,0]
    v_pk_fma_f32 v[128:129], v[128:129], s[96:97], v[132:133] op_sel_hi:[1,1,0]
    s_add_u32 s32, s32, 7168
    buffer_load_dwordx4 v57, s[60:63], s32 offen offset:3072 lds
    v_pk_fma_f32 v[130:131], v[130:131], s[96:97], v[132:133] op_sel_hi:[1,1,0]
    v_exp_f32 v116, v116
    v_exp_f32 v117, v117
    v_exp_f32 v118, v118
    v_exp_f32 v119, v119
    v_exp_f32 v120, v120
    v_exp_f32 v121, v121
    v_exp_f32 v122, v122
    v_exp_f32 v123, v123
    v_exp_f32 v124, v124
    v_exp_f32 v125, v125
    v_exp_f32 v126, v126
    v_exp_f32 v127, v127
    v_exp_f32 v128, v128
    v_exp_f32 v129, v129
    v_exp_f32 v130, v130
    v_exp_f32 v131, v131
    v_pk_add_f32 v[134:135], v[116:117], v[118:119]
    v_pk_add_f32 v[132:133], v[120:121], v[122:123]
    v_pk_add_f32 v[134:135], v[134:135], v[124:125]
    v_pk_add_f32 v[132:133], v[132:133], v[126:127]
    v_pk_add_f32 v[134:135], v[134:135], v[128:129]
    v_pk_add_f32 v[132:133], v[132:133], v[130:131]
    v_pk_add_f32 v[134:135], v[134:135], v[132:133]
    v_add_f32 v134, v134, v135
    v_rcp_f32 v134, v134
    s_nop 0
    v_pk_mul_f32 v[116:117], v[116:117], v[134:135] op_sel_hi:[1,0]
    v_pk_mul_f32 v[118:119], v[118:119], v[134:135] op_sel_hi:[1,0]
    v_pk_mul_f32 v[120:121], v[120:121], v[134:135] op_sel_hi:[1,0]
    v_pk_mul_f32 v[122:123], v[122:123], v[134:135] op_sel_hi:[1,0]
    v_pk_mul_f32 v[124:125], v[124:125], v[134:135] op_sel_hi:[1,0]
    v_pk_mul_f32 v[126:127], v[126:127], v[134:135] op_sel_hi:[1,0]
    v_pk_mul_f32 v[128:129], v[128:129], v[134:135] op_sel_hi:[1,0]
    v_pk_mul_f32 v[130:131], v[130:131], v[134:135] op_sel_hi:[1,0]
    v_cvt_pk_bf16_f32 v136, v116, v117
    v_cvt_pk_bf16_f32 v137, v118, v119
    v_cvt_pk_bf16_f32 v138, v120, v121
    v_cvt_pk_bf16_f32 v139, v122, v123
    v_cvt_pk_bf16_f32 v140, v124, v125
    v_cvt_pk_bf16_f32 v141, v126, v127
    v_cvt_pk_bf16_f32 v142, v128, v129
    v_cvt_pk_bf16_f32 v143, v130, v131
    s_mov_b32 s76, s28
    s_and_b32 s77, s29, 0xffff
    s_mov_b32 s78, 1024
    s_mov_b32 s79, 0x20000
    v_and_b32 v4, 1, v7
    v_lshlrev_b32 v4, 3, v4
    v_or_b32 v21, v4, v6
    v_lshlrev_b32 v9, 3, v8
    v_lshl_add_u32 v4, v21, 10, v9
    s_lshl_b32 s38, s80, 1
    s_add_u32 s90, s38, s95
    s_lshl_b32 s38, s90, 10
    s_lshl_b32 s39, s94, 1
    s_add_u32 s38, s38, s39
    buffer_load_dwordx2 v[102:103], v9, s[76:79], s39 offen
    s_add_u32 s39, s38, 0
    buffer_load_dwordx2 v[22:23], v4, s[40:43], s39 offen
    s_add_u32 s39, s38, 16384
    buffer_load_dwordx2 v[34:35], v4, s[40:43], s39 offen
    s_add_u32 s39, s38, 32768
    buffer_load_dwordx2 v[66:67], v4, s[40:43], s39 offen
    s_add_u32 s39, s38, 49152
    buffer_load_dwordx2 v[100:101], v4, s[40:43], s39 offen
    s_lshr_b32 s38, s95, 5
    s_mul_i32 s38, s38, 98304
    s_add_u32 s38, s38, 2097152
    s_lshl_b32 s39, s80, 14
    s_add_u32 s83, s38, s39
    s_lshl_b32 s39, s80, 13
    s_add_u32 s91, s38, s39
    s_add_u32 s91, s91, 65536
    s_lshl_b32 s39, s35, 13
    s_sub_u32 s85, s83, s39
    s_add_u32 s83, s83, s39
    s_lshl_b32 s39, s35, 12
    s_sub_u32 s3, s91, s39
    s_add_u32 s91, s91, s39
    s_waitcnt vmcnt(23)
    s_mul_i32 s86, s80, 16384
    s_add_u32 s86, s86, 73728
    v_add_u32 v58, s86, v37
    v_xor_b32 v59, 32, v58
    v_xor_b32 v60, 64, v58
    v_xor_b32 v61, 96, v58
    ds_read_b128 a[224:227], v58 offset:0
    ds_read_b128 a[228:231], v58 offset:4096
    ds_read_b128 a[232:235], v59 offset:0
    ds_read_b128 a[236:239], v59 offset:4096
    ds_read_b128 a[240:243], v60 offset:0
    ds_read_b128 a[244:247], v60 offset:4096
    ds_read_b128 a[248:251], v61 offset:0
    ds_read_b128 a[252:255], v61 offset:4096
gm_ck4:
    s_waitcnt vmcnt(19)
    v_max3_u32 v64, v24, v28, v52
    s_waitcnt vmcnt(17)
    v_max3_u32 v64, v64, v72, v76
    s_waitcnt vmcnt(15)
    v_max3_u32 v64, v64, v80, v84
    s_waitcnt vmcnt(14)
    v_max3_u32 v64, v64, v88, v92
    v_cmp_eq_u32 vcc, -1, v64
    s_nop 4
    s_cbranch_vccnz gm_rt6
gm_ok5:
    v_mfma_f32_16x16x32_bf16 v[108:111], v[68:71], v[92:95], 0
    v_mfma_f32_16x16x32_bf16 v[104:107], v[68:71], v[24:27], 0
    v_mfma_f32_16x16x32_bf16 v[104:107], v[68:71], v[28:31], v[104:107]
    v_mfma_f32_16x16x32_bf16 v[104:107], v[68:71], v[52:55], v[104:107]
    v_mfma_f32_16x16x32_bf16 v[104:107], v[68:71], v[72:75], v[104:107]
    v_mfma_f32_16x16x32_bf16 v[104:107], v[68:71], v[76:79], v[104:107]
    v_mfma_f32_16x16x32_bf16 v[104:107], v[68:71], v[80:83], v[104:107]
    v_mfma_f32_16x16x32_bf16 v[104:107], v[68:71], v[84:87], v[104:107]
    v_mfma_f32_16x16x32_bf16 v[104:107], v[68:71], v[88:91], v[104:107]
    v_add_f32 v108, v108, v108 quad_perm:[1,0,3,2] row_mask:0xf bank_mask:0xf
    v_add_f32 v109, v109, v109 quad_perm:[1,0,3,2] row_mask:0xf bank_mask:0xf
    v_add_f32 v110, v110, v110 quad_perm:[1,0,3,2] row_mask:0xf bank_mask:0xf
    v_add_f32 v111, v111, v111 quad_perm:[1,0,3,2] row_mask:0xf bank_mask:0xf
    v_add_f32 v108, v108, v108 quad_perm:[2,3,0,1] row_mask:0xf bank_mask:0xf
    v_add_f32 v109, v109, v109 quad_perm:[2,3,0,1] row_mask:0xf bank_mask:0xf
    v_add_f32 v110, v110, v110 quad_perm:[2,3,0,1] row_mask:0xf bank_mask:0xf
    v_add_f32 v111, v111, v111 quad_perm:[2,3,0,1] row_mask:0xf bank_mask:0xf
    v_add_f32 v108, v108, v108 row_half_mirror row_mask:0xf bank_mask:0xf
    v_add_f32 v109, v109, v109 row_half_mirror row_mask:0xf bank_mask:0xf
    v_add_f32 v110, v110, v110 row_half_mirror row_mask:0xf bank_mask:0xf
    v_add_f32 v111, v111, v111 row_half_mirror row_mask:0xf bank_mask:0xf
    v_cvt_pk_bf16_f32 v108, v108, v109
    v_cvt_pk_bf16_f32 v109, v110, v111
    ds_write_b64 v14, v[108:109]
    v_cvt_pk_bf16_f32 v104, v104, v105
    v_cvt_pk_bf16_f32 v105, v106, v107
    ds_write_b64 v12, v[104:105]
    s_lshl_b32 s89, s82, 12
    s_add_u32 s89, s89, s24
    s_add_u32 s89, s89, 65536
    s_waitcnt lgkmcnt(0)
    s_barrier
    ds_read_b128 v[24:27], v15 offset:0
    ds_read_b128 v[28:31], v20 offset:0
    ds_read_b128 v[52:55], v15 offset:1088
    ds_read_b128 v[72:75], v20 offset:1088
gm_ck7:
    s_waitcnt vmcnt(13)
    v_cmp_ne_u64 vcc, s[0:1], v[96:97]
    v_cmp_ne_u64 s[98:99], s[0:1], v[98:99]
    s_nop 3
    s_or_b64 vcc, vcc, s[98:99]
    s_cbranch_scc1 gm_rt9
gm_ok8:
    s_add_u32 s39, s83, 0
    buffer_load_dwordx4 v[96:99], v18, s[56:59], s39 offen offset:0 sc1
    buffer_load_dwordx4 v[128:131], v18, s[56:59], s39 offen offset:1024 sc1
    buffer_load_dwordx4 v[132:135], v18, s[56:59], s39 offen offset:2048 sc1
    buffer_load_dwordx4 v[160:163], v18, s[56:59], s39 offen offset:3072 sc1
    s_add_u32 s39, s83, 98304
    buffer_load_dwordx4 v[164:167], v18, s[56:59], s39 offen offset:0 sc1
    buffer_load_dwordx4 v[168:171], v18, s[56:59], s39 offen offset:1024 sc1
    buffer_load_dwordx4 v[172:175], v18, s[56:59], s39 offen offset:2048 sc1
    buffer_load_dwordx4 v[176:179], v18, s[56:59], s39 offen offset:3072 sc1
    s_waitcnt lgkmcnt(3)
    v_mfma_f32_32x32x16_bf16 v[112:127], v[24:27], v[44:47], 0
    s_waitcnt lgkmcnt(2)
    v_mfma_f32_32x32x16_bf16 v[112:127], v[28:31], v[48:51], v[112:127]
    s_waitcnt lgkmcnt(1)
    v_mfma_f32_32x32x16_bf16 v[144:159], v[52:55], v[136:139], 0
    s_waitcnt lgkmcnt(0)
    v_mfma_f32_32x32x16_bf16 v[144:159], v[72:75], v[140:143], v[144:159]
    s_nop 7
    v_add_f32 v120, 0x358637BD, v120
    v_rcp_f32 v120, v120
    s_nop 0
    v_mul_f32 v120, v120, v16
    v_pk_mul_f32 v[112:113], v[112:113], v[120:121] op_sel_hi:[1,0]
    v_pk_mul_f32 v[114:115], v[114:115], v[120:121] op_sel_hi:[1,0]
    v_pk_mul_f32 v[116:117], v[116:117], v[120:121] op_sel_hi:[1,0]
    v_pk_mul_f32 v[118:119], v[118:119], v[120:121] op_sel_hi:[1,0]
    v_cvt_pk_bf16_f32 v124, v112, v113
    v_cvt_pk_bf16_f32 v125, v114, v115
    v_cvt_pk_bf16_f32 v126, v116, v117
    v_cvt_pk_bf16_f32 v127, v118, v119
    buffer_store_dwordx4 v[124:127], v18, s[56:59], s89 offen offset:0 sc1
    v_add_f32 v152, 0x358637BD, v152
    v_rcp_f32 v152, v152
    s_nop 0
    v_mul_f32 v152, v152, v16
    v_pk_mul_f32 v[144:145], v[144:145], v[152:153] op_sel_hi:[1,0]
    v_pk_mul_f32 v[146:147], v[146:147], v[152:153] op_sel_hi:[1,0]
    v_pk_mul_f32 v[148:149], v[148:149], v[152:153] op_sel_hi:[1,0]
    v_pk_mul_f32 v[150:151], v[150:151], v[152:153] op_sel_hi:[1,0]
    v_cvt_pk_bf16_f32 v156, v144, v145
    v_cvt_pk_bf16_f32 v157, v146, v147
    v_cvt_pk_bf16_f32 v158, v148, v149
    v_cvt_pk_bf16_f32 v159, v150, v151
    buffer_store_dwordx4 v[156:159], v18, s[56:59], s89 offen offset:1024 sc1
    v_lshlrev_b32 v9, 2, v7
gm_ck10:
    s_waitcnt vmcnt(5)
    v_max3_u32 v64, v96, v128, v132
    s_waitcnt vmcnt(4)
    v_max_u32 v64, v64, v160
    v_cmp_eq_u32 vcc, -1, v64
    s_nop 4
    s_cbranch_vccnz gm_rt12
gm_ok11:
    v_mfma_f32_32x32x16_bf16 v[68:83], a[128:131], v[96:99], 0
    s_add_u32 s39, s83, 4096
    buffer_load_dwordx4 v[180:183], v18, s[56:59], s39 offen offset:0 sc1
    s_mul_i32 s86, s80, 16384
    s_add_u32 s86, s86, 65536
    v_add_u32 v58, s86, v39
    v_xor_b32 v59, 64, v58
    v_mfma_f32_32x32x16_bf16 v[136:151], a[132:135], v[96:99], 0
    buffer_load_dwordx4 v[184:187], v18, s[56:59], s39 offen offset:1024 sc1
    ds_read_b64_tr_b16 a[0:1], v58 offset:0
    ds_read_b64_tr_b16 a[2:3], v58 offset:512
    ds_read_b64_tr_b16 a[4:5], v59 offset:0
    ds_read_b64_tr_b16 a[6:7], v59 offset:512
    v_mfma_f32_32x32x16_bf16 v[68:83], a[136:139], v[128:131], v[68:83]
    buffer_load_dwordx4 v[188:191], v18, s[56:59], s39 offen offset:2048 sc1
    ds_read_b64_tr_b16 a[8:9], v58 offset:2048
    ds_read_b64_tr_b16 a[10:11], v58 offset:2560
    ds_read_b64_tr_b16 a[12:13], v59 offset:2048
    ds_read_b64_tr_b16 a[14:15], v59 offset:2560
    v_mfma_f32_32x32x16_bf16 v[136:151], a[140:143], v[128:131], v[136:151]
    buffer_load_dwordx4 v[208:211], v18, s[56:59], s39 offen offset:3072 sc1
    ds_read_b64_tr_b16 a[16:17], v58 offset:4096
    ds_read_b64_tr_b16 a[18:19], v58 offset:4608
    ds_read_b64_tr_b16 a[20:21], v59 offset:4096
    ds_read_b64_tr_b16 a[22:23], v59 offset:4608
    v_mfma_f32_32x32x16_bf16 v[68:83], a[144:147], v[132:135], v[68:83]
    ds_read_b64_tr_b16 a[24:25], v58 offset:6144
    ds_read_b64_tr_b16 a[26:27], v58 offset:6656
    ds_read_b64_tr_b16 a[28:29], v59 offset:6144
    ds_read_b64_tr_b16 a[30:31], v59 offset:6656
    s_mul_i32 s86, s80, 8192
    s_add_u32 s86, s86, 32768
    v_mfma_f32_32x32x16_bf16 v[136:151], a[148:151], v[132:135], v[136:151]
    v_add_u32 v58, s86, v39
    v_xor_b32 v59, 64, v58
    ds_read_b64_tr_b16 a[32:33], v58 offset:0
    ds_read_b64_tr_b16 a[34:35], v58 offset:512
    ds_read_b64_tr_b16 a[36:37], v59 offset:0
    v_mfma_f32_32x32x16_bf16 v[68:83], a[152:155], v[160:163], v[68:83]
gm_ck13:
    s_waitcnt vmcnt(5)
    v_max3_u32 v64, v164, v168, v172
    s_waitcnt vmcnt(4)
    v_max_u32 v64, v64, v176
    v_cmp_eq_u32 vcc, -1, v64
    s_nop 4
    s_cbranch_vccnz gm_rt15
gm_ok14:
    v_mfma_f32_32x32x16_bf16 v[136:151], a[156:159], v[160:163], v[136:151]
    v_mfma_f32_32x32x16_bf16 v[104:119], a[128:131], v[164:167], 0
    s_add_u32 s39, s83, 102400
    buffer_load_dwordx4 v[96:99], v18, s[56:59], s39 offen offset:0 sc1
    ds_read_b64_tr_b16 a[38:39], v59 offset:512
    ds_read_b64_tr_b16 a[40:41], v58 offset:2048
    ds_read_b64_tr_b16 a[42:43], v58 offset:2560
    v_mfma_f32_32x32x16_bf16 v[192:207], a[132:135], v[164:167], 0
    buffer_load_dwordx4 v[128:131], v18, s[56:59], s39 offen offset:1024 sc1
    ds_read_b64_tr_b16 a[44:45], v59 offset:2048
    ds_read_b64_tr_b16 a[46:47], v59 offset:2560
    ds_read_b64_tr_b16 a[48:49], v58 offset:4096
    ds_read_b64_tr_b16 a[50:51], v58 offset:4608
    v_mfma_f32_32x32x16_bf16 v[104:119], a[136:139], v[168:171], v[104:119]
    buffer_load_dwordx4 v[132:135], v18, s[56:59], s39 offen offset:2048 sc1
    ds_read_b64_tr_b16 a[52:53], v59 offset:4096
    ds_read_b64_tr_b16 a[54:55], v59 offset:4608
    ds_read_b64_tr_b16 a[56:57], v58 offset:6144
    ds_read_b64_tr_b16 a[58:59], v58 offset:6656
    v_mfma_f32_32x32x16_bf16 v[192:207], a[140:143], v[168:171], v[192:207]
    buffer_load_dwordx4 v[160:163], v18, s[56:59], s39 offen offset:3072 sc1
    ds_read_b64_tr_b16 a[60:61], v59 offset:6144
    ds_read_b64_tr_b16 a[62:63], v59 offset:6656
    v_lshlrev_b32 v52, 16, v102
    v_and_b32 v53, 0xffff0000, v102
    v_mfma_f32_32x32x16_bf16 v[104:119], a[144:147], v[172:175], v[104:119]
    v_lshlrev_b32 v54, 16, v103
    v_and_b32 v55, 0xffff0000, v103
    v_lshlrev_b32 v24, 16, v22
    v_and_b32 v25, 0xffff0000, v22
    v_lshlrev_b32 v26, 16, v23
    v_mfma_f32_32x32x16_bf16 v[192:207], a[148:151], v[172:175], v[192:207]
    v_and_b32 v27, 0xffff0000, v23
    v_mul_f32 v24, v24, v52
    v_mul_f32 v25, v25, v53
    v_mul_f32 v26, v26, v54
    v_mul_f32 v27, v27, v55
    v_mfma_f32_32x32x16_bf16 v[104:119], a[152:155], v[176:179], v[104:119]
gm_ck16:
    s_waitcnt vmcnt(5)
    v_max3_u32 v64, v180, v184, v188
    s_waitcnt vmcnt(4)
    v_max_u32 v64, v64, v208
    v_cmp_eq_u32 vcc, -1, v64
    s_nop 4
    s_cbranch_vccnz gm_rt18
gm_ok17:
    v_mfma_f32_32x32x16_bf16 v[192:207], a[156:159], v[176:179], v[192:207]
    v_mfma_f32_32x32x16_bf16 v[68:83], a[160:163], v[180:183], v[68:83]
    s_add_u32 s39, s85, 8192
    buffer_load_dwordx4 v[164:167], v18, s[56:59], s39 offen offset:0 sc1
    v_cvt_pk_bf16_f32 v22, v24, v25
    v_cvt_pk_bf16_f32 v23, v26, v27
    v_lshlrev_b32 v24, 16, v22
    v_mfma_f32_32x32x16_bf16 v[136:151], a[164:167], v[180:183], v[136:151]
    buffer_load_dwordx4 v[168:171], v18, s[56:59], s39 offen offset:1024 sc1
    v_and_b32 v25, 0xffff0000, v22
    v_lshlrev_b32 v26, 16, v23
    v_and_b32 v27, 0xffff0000, v23
    v_lshlrev_b32 v28, 16, v34
    v_mfma_f32_32x32x16_bf16 v[68:83], a[168:171], v[184:187], v[68:83]
    buffer_load_dwordx4 v[172:175], v18, s[56:59], s39 offen offset:2048 sc1
    v_and_b32 v29, 0xffff0000, v34
    v_lshlrev_b32 v30, 16, v35
    v_and_b32 v31, 0xffff0000, v35
    v_mul_f32 v28, v28, v52
    v_mfma_f32_32x32x16_bf16 v[136:151], a[172:175], v[184:187], v[136:151]
    buffer_load_dwordx4 v[176:179], v18, s[56:59], s39 offen offset:3072 sc1
    v_mul_f32 v29, v29, v53
    v_mul_f32 v30, v30, v54
    v_mul_f32 v31, v31, v55
    v_cvt_pk_bf16_f32 v34, v28, v29
    v_mfma_f32_32x32x16_bf16 v[68:83], a[176:179], v[188:191], v[68:83]
    s_lshr_b32 s88, s95, 6
    s_lshl_b32 s88, s88, 8
    s_lshl_b32 s89, s80, 5
    s_add_u32 s88, s88, s89
    s_add_u32 s88, s88, 720896
    buffer_load_dword v10, v9, s[56:59], s88 offen offset:0 sc1
    v_cvt_pk_bf16_f32 v35, v30, v31
    v_mfma_f32_32x32x16_bf16 v[136:151], a[180:183], v[188:191], v[136:151]
    buffer_load_dword v11, v9, s[56:59], s88 offen offset:16 sc1
    v_lshlrev_b32 v28, 16, v34
    v_and_b32 v29, 0xffff0000, v34
    v_lshlrev_b32 v30, 16, v35
    v_and_b32 v31, 0xffff0000, v35
    v_mfma_f32_32x32x16_bf16 v[68:83], a[184:187], v[208:211], v[68:83]
    buffer_load_dword v12, v9, s[56:59], s88 offen offset:128 sc1
gm_ck19:
    s_waitcnt vmcnt(8)
    v_max3_u32 v64, v96, v128, v132
    s_waitcnt vmcnt(7)
    v_max_u32 v64, v64, v160
    v_cmp_eq_u32 vcc, -1, v64
    s_nop 4
    s_cbranch_vccnz gm_rt21
gm_ok20:
    v_mfma_f32_32x32x16_bf16 v[136:151], a[188:191], v[208:211], v[136:151]
    buffer_load_dword v14, v9, s[56:59], s88 offen offset:144 sc1
    v_mfma_f32_32x32x16_bf16 v[104:119], a[160:163], v[96:99], v[104:119]
    s_add_u32 s39, s85, 106496
    buffer_load_dwordx4 v[180:183], v18, s[56:59], s39 offen offset:0 sc1
    v_lshlrev_b32 v44, 16, v66
    v_and_b32 v45, 0xffff0000, v66
    v_lshlrev_b32 v46, 16, v67
    v_mfma_f32_32x32x16_bf16 v[192:207], a[164:167], v[96:99], v[192:207]
    buffer_load_dwordx4 v[184:187], v18, s[56:59], s39 offen offset:1024 sc1
    v_and_b32 v47, 0xffff0000, v67
    v_mul_f32 v44, v44, v52
    v_mul_f32 v45, v45, v53
    v_mul_f32 v46, v46, v54
    v_mfma_f32_32x32x16_bf16 v[104:119], a[168:171], v[128:131], v[104:119]
    buffer_load_dwordx4 v[188:191], v18, s[56:59], s39 offen offset:2048 sc1
    v_mul_f32 v47, v47, v55
    v_cvt_pk_bf16_f32 v66, v44, v45
    v_cvt_pk_bf16_f32 v67, v46, v47
    v_lshlrev_b32 v44, 16, v66
    v_mfma_f32_32x32x16_bf16 v[192:207], a[172:175], v[128:131], v[192:207]
    buffer_load_dwordx4 v[208:211], v18, s[56:59], s39 offen offset:3072 sc1
    v_and_b32 v45, 0xffff0000, v66
    v_lshlrev_b32 v46, 16, v67
    v_and_b32 v47, 0xffff0000, v67
    v_lshlrev_b32 v48, 16, v100
    v_mfma_f32_32x32x16_bf16 v[104:119], a[176:179], v[132:135], v[104:119]
    v_and_b32 v49, 0xffff0000, v100
    v_lshlrev_b32 v50, 16, v101
    v_and_b32 v51, 0xffff0000, v101
    v_mul_f32 v48, v48, v52
    v_mul_f32 v49, v49, v53
    v_mfma_f32_32x32x16_bf16 v[192:207], a[180:183], v[132:135], v[192:207]
    v_mul_f32 v50, v50, v54
    v_mul_f32 v51, v51, v55
    v_cvt_pk_bf16_f32 v100, v48, v49
    v_cvt_pk_bf16_f32 v101, v50, v51
    v_lshlrev_b32 v48, 16, v100
    v_mfma_f32_32x32x16_bf16 v[104:119], a[184:187], v[160:163], v[104:119]
gm_ck22:
    s_waitcnt vmcnt(9)
    v_max3_u32 v64, v164, v168, v172
    s_waitcnt vmcnt(8)
    v_max_u32 v64, v64, v176
    v_cmp_eq_u32 vcc, -1, v64
    s_nop 4
    s_cbranch_vccnz gm_rt24
gm_ok23:
    v_mfma_f32_32x32x16_bf16 v[192:207], a[188:191], v[160:163], v[192:207]
    v_mfma_f32_32x32x16_bf16 v[68:83], a[192:195], v[164:167], v[68:83]
    s_add_u32 s39, s85, 12288
    buffer_load_dwordx4 v[96:99], v18, s[56:59], s39 offen offset:0 sc1
    v_and_b32 v49, 0xffff0000, v100
    v_lshlrev_b32 v50, 16, v101
    v_and_b32 v51, 0xffff0000, v101
    v_mfma_f32_32x32x16_bf16 v[136:151], a[196:199], v[164:167], v[136:151]
    buffer_load_dwordx4 v[128:131], v18, s[56:59], s39 offen offset:1024 sc1
    v_and_b32 v4, 7, v5
    v_xor_b32 v4, v4, v6
    v_lshlrev_b32 v4, 4, v4
    v_lshl_add_u32 v4, v5, 8, v4
    v_mfma_f32_32x32x16_bf16 v[68:83], a[200:203], v[168:171], v[68:83]
    buffer_load_dwordx4 v[132:135], v18, s[56:59], s39 offen offset:2048 sc1
    s_lshl_b32 s86, s80, 14
    s_add_u32 s86, s86, 65536
    v_add_u32 v15, s86, v4
    v_xor_b32 v16, 32, v15
    v_xor_b32 v20, 64, v15
    v_mfma_f32_32x32x16_bf16 v[136:151], a[204:207], v[168:171], v[136:151]
    buffer_load_dwordx4 v[160:163], v18, s[56:59], s39 offen offset:3072 sc1
    v_xor_b32 v33, 96, v15
    v_xor_b32 v4, v8, v7
    v_lshlrev_b32 v4, 4, v4
    v_lshl_add_u32 v4, v7, 8, v4
    v_mfma_f32_32x32x16_bf16 v[68:83], a[208:211], v[172:175], v[68:83]
    s_lshl_b32 s86, s80, 11
    s_add_u32 s86, s86, 65536
    v_add_u32 v36, s86, v4
    v_xor_b32 v43, 64, v36
    v_lshlrev_b32 v4, 4, v8
    v_lshl_add_u32 v62, v21, 11, v4
    v_mfma_f32_32x32x16_bf16 v[136:151], a[212:215], v[172:175], v[136:151]
    s_lshl_b32 s86, s90, 11
    s_lshl_b32 s87, s94, 2
    s_add_u32 s86, s86, s87
    v_mfma_f32_32x32x16_bf16 v[68:83], a[216:219], v[176:179], v[68:83]
gm_ck25:
    s_waitcnt vmcnt(5)
    v_max3_u32 v64, v180, v184, v188
    s_waitcnt vmcnt(4)
    v_max_u32 v64, v64, v208
    v_cmp_eq_u32 vcc, -1, v64
    s_nop 4
    s_cbranch_vccnz gm_rt27
gm_ok26:
    v_mfma_f32_32x32x16_bf16 v[136:151], a[220:223], v[176:179], v[136:151]
    v_mfma_f32_32x32x16_bf16 v[104:119], a[192:195], v[180:183], v[104:119]
    s_add_u32 s39, s85, 110592
    buffer_load_dwordx4 v[164:167], v18, s[56:59], s39 offen offset:0 sc1
    v_mfma_f32_32x32x16_bf16 v[192:207], a[196:199], v[180:183], v[192:207]
    buffer_load_dwordx4 v[168:171], v18, s[56:59], s39 offen offset:1024 sc1
    v_mfma_f32_32x32x16_bf16 v[104:119], a[200:203], v[184:187], v[104:119]
    buffer_load_dwordx4 v[172:175], v18, s[56:59], s39 offen offset:2048 sc1
    v_mfma_f32_32x32x16_bf16 v[192:207], a[204:207], v[184:187], v[192:207]
    buffer_load_dwordx4 v[176:179], v18, s[56:59], s39 offen offset:3072 sc1
    v_mfma_f32_32x32x16_bf16 v[104:119], a[208:211], v[188:191], v[104:119]
    v_mfma_f32_32x32x16_bf16 v[192:207], a[212:215], v[188:191], v[192:207]
    v_mfma_f32_32x32x16_bf16 v[104:119], a[216:219], v[208:211], v[104:119]
gm_ck28:
    s_waitcnt vmcnt(5)
    v_max3_u32 v64, v96, v128, v132
    s_waitcnt vmcnt(4)
    v_max_u32 v64, v64, v160
    v_cmp_eq_u32 vcc, -1, v64
    s_nop 4
    s_cbranch_vccnz gm_rt30
gm_ok29:
    v_mfma_f32_32x32x16_bf16 v[192:207], a[220:223], v[208:211], v[192:207]
    v_mfma_f32_32x32x16_bf16 v[68:83], a[224:227], v[96:99], v[68:83]
    s_add_u32 s39, s91, 0
    buffer_load_dwordx4 v[180:183], v18, s[56:59], s39 offen offset:0 sc1
    v_mfma_f32_32x32x16_bf16 v[136:151], a[228:231], v[96:99], v[136:151]
    buffer_load_dwordx4 v[184:187], v18, s[56:59], s39 offen offset:1024 sc1
    v_mfma_f32_32x32x16_bf16 v[68:83], a[232:235], v[128:131], v[68:83]
    buffer_load_dwordx4 v[188:191], v18, s[56:59], s39 offen offset:2048 sc1
    v_mfma_f32_32x32x16_bf16 v[136:151], a[236:239], v[128:131], v[136:151]
    buffer_load_dwordx4 v[208:211], v18, s[56:59], s39 offen offset:3072 sc1
    v_mfma_f32_32x32x16_bf16 v[68:83], a[240:243], v[132:135], v[68:83]
    v_mfma_f32_32x32x16_bf16 v[136:151], a[244:247], v[132:135], v[136:151]
    v_mfma_f32_32x32x16_bf16 v[68:83], a[248:251], v[160:163], v[68:83]
gm_ck31:
    s_waitcnt vmcnt(5)
    v_max3_u32 v64, v164, v168, v172
    s_waitcnt vmcnt(4)
    v_max_u32 v64, v64, v176
    v_cmp_eq_u32 vcc, -1, v64
    s_nop 4
    s_cbranch_vccnz gm_rt33
gm_ok32:
    v_mfma_f32_32x32x16_bf16 v[136:151], a[252:255], v[160:163], v[136:151]
    v_mfma_f32_32x32x16_bf16 v[104:119], a[224:227], v[164:167], v[104:119]
    s_add_u32 s39, s3, 4096
    buffer_load_dwordx4 v[96:99], v18, s[56:59], s39 offen offset:0 sc1
    v_mfma_f32_32x32x16_bf16 v[192:207], a[228:231], v[164:167], v[192:207]
    buffer_load_dwordx4 v[128:131], v18, s[56:59], s39 offen offset:1024 sc1
    v_mfma_f32_32x32x16_bf16 v[104:119], a[232:235], v[168:171], v[104:119]
    buffer_load_dwordx4 v[132:135], v18, s[56:59], s39 offen offset:2048 sc1
    v_mfma_f32_32x32x16_bf16 v[192:207], a[236:239], v[168:171], v[192:207]
    buffer_load_dwordx4 v[160:163], v18, s[56:59], s39 offen offset:3072 sc1
    v_mfma_f32_32x32x16_bf16 v[104:119], a[240:243], v[172:175], v[104:119]
    v_mfma_f32_32x32x16_bf16 v[192:207], a[244:247], v[172:175], v[192:207]
    v_mfma_f32_32x32x16_bf16 v[104:119], a[248:251], v[176:179], v[104:119]
gm_ck34:
    s_waitcnt vmcnt(5)
    v_max3_u32 v64, v180, v184, v188
    s_waitcnt vmcnt(4)
    v_max_u32 v64, v64, v208
    v_cmp_eq_u32 vcc, -1, v64
    s_nop 4
    s_cbranch_vccnz gm_rt36
gm_ok35:
    v_mfma_f32_32x32x16_bf16 v[192:207], a[252:255], v[176:179], v[192:207]
    s_waitcnt lgkmcnt(15)
    v_mfma_f32_32x32x16_bf16 v[68:83], a[0:3], v[180:183], v[68:83]
    s_add_u32 s39, s91, 98304
    buffer_load_dwordx4 v[164:167], v18, s[56:59], s39 offen offset:0 sc1
    v_mfma_f32_32x32x16_bf16 v[136:151], a[4:7], v[180:183], v[136:151]
    buffer_load_dwordx4 v[168:171], v18, s[56:59], s39 offen offset:1024 sc1
    v_mfma_f32_32x32x16_bf16 v[68:83], a[8:11], v[184:187], v[68:83]
    buffer_load_dwordx4 v[172:175], v18, s[56:59], s39 offen offset:2048 sc1
    v_mfma_f32_32x32x16_bf16 v[136:151], a[12:15], v[184:187], v[136:151]
    buffer_load_dwordx4 v[176:179], v18, s[56:59], s39 offen offset:3072 sc1
    v_mfma_f32_32x32x16_bf16 v[68:83], a[16:19], v[188:191], v[68:83]
    v_mfma_f32_32x32x16_bf16 v[136:151], a[20:23], v[188:191], v[136:151]
    v_mfma_f32_32x32x16_bf16 v[68:83], a[24:27], v[208:211], v[68:83]
gm_ck37:
    s_waitcnt vmcnt(5)
    v_max3_u32 v64, v96, v128, v132
    s_waitcnt vmcnt(4)
    v_max_u32 v64, v64, v160
    v_cmp_eq_u32 vcc, -1, v64
    s_nop 4
    s_cbranch_vccnz gm_rt39
gm_ok38:
    v_mfma_f32_32x32x16_bf16 v[136:151], a[28:31], v[208:211], v[136:151]
    s_waitcnt lgkmcnt(14)
    v_mfma_f32_32x32x16_bf16 v[68:83], a[32:35], v[96:99], v[68:83]
    s_add_u32 s39, s3, 102400
    buffer_load_dwordx4 v[180:183], v18, s[56:59], s39 offen offset:0 sc1
gm_ck40:
    v_max3_u32 v64, v10, v11, v12
    v_max_u32 v64, v64, v14
    v_cmp_eq_u32 vcc, -1, v64
    s_nop 4
    s_cbranch_vccnz gm_rt42
gm_ok41:
    v_mul_f32 v24, v24, v10
    v_mul_f32 v25, v25, v10
    v_mul_f32 v26, v26, v10
    s_waitcnt lgkmcnt(12)
    v_mfma_f32_32x32x16_bf16 v[136:151], a[36:39], v[96:99], v[136:151]
    buffer_load_dwordx4 v[184:187], v18, s[56:59], s39 offen offset:1024 sc1
    v_mul_f32 v27, v27, v10
    v_mul_f32 v28, v28, v11
    v_mul_f32 v29, v29, v11
    v_mul_f32 v30, v30, v11
    s_waitcnt lgkmcnt(10)
    v_mfma_f32_32x32x16_bf16 v[68:83], a[40:43], v[128:131], v[68:83]
    buffer_load_dwordx4 v[188:191], v18, s[56:59], s39 offen offset:2048 sc1
    v_mul_f32 v31, v31, v11
    v_mul_f32 v44, v44, v12
    v_mul_f32 v45, v45, v12
    v_mul_f32 v46, v46, v12
    s_waitcnt lgkmcnt(8)
    v_mfma_f32_32x32x16_bf16 v[136:151], a[44:47], v[128:131], v[136:151]
    buffer_load_dwordx4 v[208:211], v18, s[56:59], s39 offen offset:3072 sc1
    v_mul_f32 v47, v47, v12
    v_mul_f32 v48, v48, v14
    v_mul_f32 v49, v49, v14
    v_mul_f32 v50, v50, v14
    s_waitcnt lgkmcnt(6)
    v_mfma_f32_32x32x16_bf16 v[68:83], a[48:51], v[132:135], v[68:83]
    v_mul_f32 v51, v51, v14
    s_waitcnt lgkmcnt(4)
    v_mfma_f32_32x32x16_bf16 v[136:151], a[52:55], v[132:135], v[136:151]
    s_waitcnt lgkmcnt(2)
    v_mfma_f32_32x32x16_bf16 v[68:83], a[56:59], v[160:163], v[68:83]
gm_ck43:
    s_waitcnt vmcnt(5)
    v_max3_u32 v64, v164, v168, v172
    s_waitcnt vmcnt(4)
    v_max_u32 v64, v64, v176
    v_cmp_eq_u32 vcc, -1, v64
    s_nop 4
    s_cbranch_vccnz gm_rt45
gm_ok44:
    s_waitcnt lgkmcnt(0)
    v_mfma_f32_32x32x16_bf16 v[136:151], a[60:63], v[160:163], v[136:151]
    v_mfma_f32_32x32x16_bf16 v[104:119], a[0:3], v[164:167], v[104:119]
    ds_write_b128 v15, v[68:71] offset:0
    v_mfma_f32_32x32x16_bf16 v[192:207], a[4:7], v[164:167], v[192:207]
    ds_write_b128 v16, v[72:75] offset:0
    v_mfma_f32_32x32x16_bf16 v[104:119], a[8:11], v[168:171], v[104:119]
    ds_write_b128 v20, v[76:79] offset:0
    v_mfma_f32_32x32x16_bf16 v[192:207], a[12:15], v[168:171], v[192:207]
    ds_write_b128 v33, v[80:83] offset:0
    v_mfma_f32_32x32x16_bf16 v[104:119], a[16:19], v[172:175], v[104:119]
    s_nop 2
    ds_write_b128 v15, v[136:139] offset:128
    v_mfma_f32_32x32x16_bf16 v[192:207], a[20:23], v[172:175], v[192:207]
    ds_write_b128 v16, v[140:143] offset:128
    v_mfma_f32_32x32x16_bf16 v[104:119], a[24:27], v[176:179], v[104:119]
    ds_write_b128 v20, v[144:147] offset:128
gm_ck46:
    s_waitcnt vmcnt(1)
    v_max3_u32 v64, v180, v184, v188
    s_waitcnt vmcnt(0)
    v_max_u32 v64, v64, v208
    v_cmp_eq_u32 vcc, -1, v64
    s_nop 4
    s_cbranch_vccnz gm_rt48
gm_ok47:
    v_mfma_f32_32x32x16_bf16 v[192:207], a[28:31], v[176:179], v[192:207]
    ds_write_b128 v33, v[148:151] offset:128
    v_mfma_f32_32x32x16_bf16 v[104:119], a[32:35], v[180:183], v[104:119]
    v_mfma_f32_32x32x16_bf16 v[192:207], a[36:39], v[180:183], v[192:207]
    s_waitcnt lgkmcnt(0)
    s_barrier
    ds_read_b128 v[68:71], v36 offset:0
    ds_read_b128 v[72:75], v36 offset:16384
    v_mfma_f32_32x32x16_bf16 v[104:119], a[40:43], v[184:187], v[104:119]
    ds_read_b128 v[76:79], v36 offset:32768
    ds_read_b128 v[80:83], v36 offset:49152
    v_mfma_f32_32x32x16_bf16 v[192:207], a[44:47], v[184:187], v[192:207]
    ds_read_b128 v[136:139], v43 offset:1024
    ds_read_b128 v[140:143], v43 offset:17408
    v_mfma_f32_32x32x16_bf16 v[104:119], a[48:51], v[188:191], v[104:119]
    ds_read_b128 v[144:147], v43 offset:33792
    ds_read_b128 v[148:151], v43 offset:50176
    v_mfma_f32_32x32x16_bf16 v[192:207], a[52:55], v[188:191], v[192:207]
    v_mfma_f32_32x32x16_bf16 v[104:119], a[56:59], v[208:211], v[104:119]
    v_mfma_f32_32x32x16_bf16 v[192:207], a[60:63], v[208:211], v[192:207]
    s_nop 10
    ds_write_b128 v15, v[104:107] offset:8192
    ds_write_b128 v16, v[108:111] offset:8192
    ds_write_b128 v20, v[112:115] offset:8192
    ds_write_b128 v33, v[116:119] offset:8192
    ds_write_b128 v15, v[192:195] offset:8320
    ds_write_b128 v16, v[196:199] offset:8320
    ds_write_b128 v20, v[200:203] offset:8320
    ds_write_b128 v33, v[204:207] offset:8320
    s_waitcnt lgkmcnt(14)
    v_pk_add_f32 v[68:69], v[68:69], v[72:73]
    v_pk_add_f32 v[70:71], v[70:71], v[74:75]
    s_waitcnt lgkmcnt(12)
    v_pk_add_f32 v[76:77], v[76:77], v[80:81]
    v_pk_add_f32 v[78:79], v[78:79], v[82:83]
    v_pk_add_f32 v[24:25], v[24:25], v[68:69]
    v_pk_add_f32 v[26:27], v[26:27], v[70:71]
    v_pk_add_f32 v[24:25], v[24:25], v[76:77]
    v_pk_add_f32 v[26:27], v[26:27], v[78:79]
    s_add_u32 s38, s86, 0
    buffer_store_dwordx4 v[24:27], v62, s[72:75], s38 offen sc1
    s_waitcnt lgkmcnt(10)
    v_pk_add_f32 v[136:137], v[136:137], v[140:141]
    v_pk_add_f32 v[138:139], v[138:139], v[142:143]
    s_waitcnt lgkmcnt(8)
    v_pk_add_f32 v[144:145], v[144:145], v[148:149]
    v_pk_add_f32 v[146:147], v[146:147], v[150:151]
    v_pk_add_f32 v[28:29], v[28:29], v[136:137]
    v_pk_add_f32 v[30:31], v[30:31], v[138:139]
    v_pk_add_f32 v[28:29], v[28:29], v[144:145]
    v_pk_add_f32 v[30:31], v[30:31], v[146:147]
    s_add_u32 s38, s86, 32768
    buffer_store_dwordx4 v[28:31], v62, s[72:75], s38 offen sc1
    s_waitcnt lgkmcnt(0)
    s_barrier
    ds_read_b128 v[104:107], v36 offset:8192
    ds_read_b128 v[108:111], v36 offset:24576
    ds_read_b128 v[112:115], v36 offset:40960
    ds_read_b128 v[116:119], v36 offset:57344
    ds_read_b128 v[192:195], v43 offset:9216
    ds_read_b128 v[196:199], v43 offset:25600
    ds_read_b128 v[200:203], v43 offset:41984
    ds_read_b128 v[204:207], v43 offset:58368
    s_waitcnt lgkmcnt(6)
    v_pk_add_f32 v[104:105], v[104:105], v[108:109]
    v_pk_add_f32 v[106:107], v[106:107], v[110:111]
    s_waitcnt lgkmcnt(4)
    v_pk_add_f32 v[112:113], v[112:113], v[116:117]
    v_pk_add_f32 v[114:115], v[114:115], v[118:119]
    v_pk_add_f32 v[44:45], v[44:45], v[104:105]
    v_pk_add_f32 v[46:47], v[46:47], v[106:107]
    v_pk_add_f32 v[44:45], v[44:45], v[112:113]
    v_pk_add_f32 v[46:47], v[46:47], v[114:115]
    s_add_u32 s38, s86, 65536
    buffer_store_dwordx4 v[44:47], v62, s[72:75], s38 offen sc1
    s_waitcnt lgkmcnt(2)
    v_pk_add_f32 v[192:193], v[192:193], v[196:197]
    v_pk_add_f32 v[194:195], v[194:195], v[198:199]
    s_waitcnt lgkmcnt(0)
    v_pk_add_f32 v[200:201], v[200:201], v[204:205]
    v_pk_add_f32 v[202:203], v[202:203], v[206:207]
    v_pk_add_f32 v[48:49], v[48:49], v[192:193]
    v_pk_add_f32 v[50:51], v[50:51], v[194:195]
    v_pk_add_f32 v[48:49], v[48:49], v[200:201]
    v_pk_add_f32 v[50:51], v[50:51], v[202:203]
    s_add_u32 s38, s86, 98304
    buffer_store_dwordx4 v[48:51], v62, s[72:75], s38 offen sc1
    s_add_u32 s38, s95, s94
    s_add_u32 s38, s38, s80
    s_cmp_eq_u32 s94, 0
    s_cselect_b32 s38, s38, 0
    s_cmp_eq_u32 s38, 1920
    s_cselect_b32 s38, 0, 2147418112
    buffer_store_dword v17, v63, s[56:59], s38 offen sc1
    s_endpgm
gm_rt3:
    s_add_u32 s92, s92, 1
    s_cmp_ge_u32 s92, 100000
    s_cbranch_scc1 gm_ok2
    s_mov_b32 s39, 4096
    buffer_load_dwordx4 v[24:27], v18, s[56:59], s39 offen sc1
    s_waitcnt vmcnt(0)
    s_branch gm_ck1
gm_rt6:
    s_add_u32 s92, s92, 1
    s_cmp_ge_u32 s92, 100000
    s_cbranch_scc1 gm_ok5
    buffer_load_dwordx4 v[92:95], v10, s[56:59], 0 offen sc1
    buffer_load_dwordx4 v[24:27], v11, s[56:59], 0 offen offset:0 sc1
    buffer_load_dwordx4 v[28:31], v11, s[56:59], 0 offen offset:2048 sc1
    s_mov_b32 s38, 4096
    buffer_load_dwordx4 v[52:55], v11, s[56:59], s38 offen offset:0 sc1
    buffer_load_dwordx4 v[72:75], v11, s[56:59], s38 offen offset:2048 sc1
    s_mov_b32 s38, 8192
    buffer_load_dwordx4 v[76:79], v11, s[56:59], s38 offen offset:0 sc1
    buffer_load_dwordx4 v[80:83], v11, s[56:59], s38 offen offset:2048 sc1
    s_mov_b32 s38, 12288
    buffer_load_dwordx4 v[84:87], v11, s[56:59], s38 offen offset:0 sc1
    buffer_load_dwordx4 v[88:91], v11, s[56:59], s38 offen offset:2048 sc1
    s_waitcnt vmcnt(0)
    s_branch gm_ck4
gm_rt9:
    s_add_u32 s92, s92, 1
    s_cmp_ge_u32 s92, 100000
    s_cbranch_scc1 gm_ok8
    s_mov_b32 s39, 5120
    buffer_load_dwordx4 v[96:99], v18, s[56:59], s39 offen sc1
    s_waitcnt vmcnt(0)
    s_branch gm_ck7
gm_rt12:
    s_add_u32 s92, s92, 1
    s_cmp_ge_u32 s92, 100000
    s_cbranch_scc1 gm_ok11
    s_add_u32 s39, s83, 0
    buffer_load_dwordx4 v[96:99], v18, s[56:59], s39 offen offset:0 sc1
    buffer_load_dwordx4 v[128:131], v18, s[56:59], s39 offen offset:1024 sc1
    buffer_load_dwordx4 v[132:135], v18, s[56:59], s39 offen offset:2048 sc1
    buffer_load_dwordx4 v[160:163], v18, s[56:59], s39 offen offset:3072 sc1
    s_add_u32 s39, s83, 98304
    buffer_load_dwordx4 v[164:167], v18, s[56:59], s39 offen offset:0 sc1
    buffer_load_dwordx4 v[168:171], v18, s[56:59], s39 offen offset:1024 sc1
    buffer_load_dwordx4 v[172:175], v18, s[56:59], s39 offen offset:2048 sc1
    buffer_load_dwordx4 v[176:179], v18, s[56:59], s39 offen offset:3072 sc1
    s_waitcnt vmcnt(4)
    s_branch gm_ck10
gm_rt15:
    s_add_u32 s92, s92, 1
    s_cmp_ge_u32 s92, 100000
    s_cbranch_scc1 gm_ok14
    s_add_u32 s39, s83, 98304
    buffer_load_dwordx4 v[164:167], v18, s[56:59], s39 offen offset:0 sc1
    buffer_load_dwordx4 v[168:171], v18, s[56:59], s39 offen offset:1024 sc1
    buffer_load_dwordx4 v[172:175], v18, s[56:59], s39 offen offset:2048 sc1
    buffer_load_dwordx4 v[176:179], v18, s[56:59], s39 offen offset:3072 sc1
    s_add_u32 s39, s83, 4096
    buffer_load_dwordx4 v[180:183], v18, s[56:59], s39 offen offset:0 sc1
    buffer_load_dwordx4 v[184:187], v18, s[56:59], s39 offen offset:1024 sc1
    buffer_load_dwordx4 v[188:191], v18, s[56:59], s39 offen offset:2048 sc1
    buffer_load_dwordx4 v[208:211], v18, s[56:59], s39 offen offset:3072 sc1
    s_waitcnt vmcnt(4)
    s_branch gm_ck13
gm_rt18:
    s_add_u32 s92, s92, 1
    s_cmp_ge_u32 s92, 100000
    s_cbranch_scc1 gm_ok17
    s_add_u32 s39, s83, 4096
    buffer_load_dwordx4 v[180:183], v18, s[56:59], s39 offen offset:0 sc1
    buffer_load_dwordx4 v[184:187], v18, s[56:59], s39 offen offset:1024 sc1
    buffer_load_dwordx4 v[188:191], v18, s[56:59], s39 offen offset:2048 sc1
    buffer_load_dwordx4 v[208:211], v18, s[56:59], s39 offen offset:3072 sc1
    s_add_u32 s39, s83, 102400
    buffer_load_dwordx4 v[96:99], v18, s[56:59], s39 offen offset:0 sc1
    buffer_load_dwordx4 v[128:131], v18, s[56:59], s39 offen offset:1024 sc1
    buffer_load_dwordx4 v[132:135], v18, s[56:59], s39 offen offset:2048 sc1
    buffer_load_dwordx4 v[160:163], v18, s[56:59], s39 offen offset:3072 sc1
    s_waitcnt vmcnt(4)
    s_branch gm_ck16
gm_rt21:
    s_add_u32 s92, s92, 1
    s_cmp_ge_u32 s92, 100000
    s_cbranch_scc1 gm_ok20
    s_add_u32 s39, s83, 102400
    buffer_load_dwordx4 v[96:99], v18, s[56:59], s39 offen offset:0 sc1
    buffer_load_dwordx4 v[128:131], v18, s[56:59], s39 offen offset:1024 sc1
    buffer_load_dwordx4 v[132:135], v18, s[56:59], s39 offen offset:2048 sc1
    buffer_load_dwordx4 v[160:163], v18, s[56:59], s39 offen offset:3072 sc1
    s_add_u32 s39, s85, 8192
    buffer_load_dwordx4 v[164:167], v18, s[56:59], s39 offen offset:0 sc1
    buffer_load_dwordx4 v[168:171], v18, s[56:59], s39 offen offset:1024 sc1
    buffer_load_dwordx4 v[172:175], v18, s[56:59], s39 offen offset:2048 sc1
    buffer_load_dwordx4 v[176:179], v18, s[56:59], s39 offen offset:3072 sc1
    s_waitcnt vmcnt(0)
    s_branch gm_ck19
gm_rt24:
    s_add_u32 s92, s92, 1
    s_cmp_ge_u32 s92, 100000
    s_cbranch_scc1 gm_ok23
    s_add_u32 s39, s85, 8192
    buffer_load_dwordx4 v[164:167], v18, s[56:59], s39 offen offset:0 sc1
    buffer_load_dwordx4 v[168:171], v18, s[56:59], s39 offen offset:1024 sc1
    buffer_load_dwordx4 v[172:175], v18, s[56:59], s39 offen offset:2048 sc1
    buffer_load_dwordx4 v[176:179], v18, s[56:59], s39 offen offset:3072 sc1
    s_add_u32 s39, s85, 106496
    buffer_load_dwordx4 v[180:183], v18, s[56:59], s39 offen offset:0 sc1
    buffer_load_dwordx4 v[184:187], v18, s[56:59], s39 offen offset:1024 sc1
    buffer_load_dwordx4 v[188:191], v18, s[56:59], s39 offen offset:2048 sc1
    buffer_load_dwordx4 v[208:211], v18, s[56:59], s39 offen offset:3072 sc1
    s_waitcnt vmcnt(4)
    s_branch gm_ck22
gm_rt27:
    s_add_u32 s92, s92, 1
    s_cmp_ge_u32 s92, 100000
    s_cbranch_scc1 gm_ok26
    s_add_u32 s39, s85, 106496
    buffer_load_dwordx4 v[180:183], v18, s[56:59], s39 offen offset:0 sc1
    buffer_load_dwordx4 v[184:187], v18, s[56:59], s39 offen offset:1024 sc1
    buffer_load_dwordx4 v[188:191], v18, s[56:59], s39 offen offset:2048 sc1
    buffer_load_dwordx4 v[208:211], v18, s[56:59], s39 offen offset:3072 sc1
    s_add_u32 s39, s85, 12288
    buffer_load_dwordx4 v[96:99], v18, s[56:59], s39 offen offset:0 sc1
    buffer_load_dwordx4 v[128:131], v18, s[56:59], s39 offen offset:1024 sc1
    buffer_load_dwordx4 v[132:135], v18, s[56:59], s39 offen offset:2048 sc1
    buffer_load_dwordx4 v[160:163], v18, s[56:59], s39 offen offset:3072 sc1
    s_waitcnt vmcnt(4)
    s_branch gm_ck25
gm_rt30:
    s_add_u32 s92, s92, 1
    s_cmp_ge_u32 s92, 100000
    s_cbranch_scc1 gm_ok29
    s_add_u32 s39, s85, 12288
    buffer_load_dwordx4 v[96:99], v18, s[56:59], s39 offen offset:0 sc1
    buffer_load_dwordx4 v[128:131], v18, s[56:59], s39 offen offset:1024 sc1
    buffer_load_dwordx4 v[132:135], v18, s[56:59], s39 offen offset:2048 sc1
    buffer_load_dwordx4 v[160:163], v18, s[56:59], s39 offen offset:3072 sc1
    s_add_u32 s39, s85, 110592
    buffer_load_dwordx4 v[164:167], v18, s[56:59], s39 offen offset:0 sc1
    buffer_load_dwordx4 v[168:171], v18, s[56:59], s39 offen offset:1024 sc1
    buffer_load_dwordx4 v[172:175], v18, s[56:59], s39 offen offset:2048 sc1
    buffer_load_dwordx4 v[176:179], v18, s[56:59], s39 offen offset:3072 sc1
    s_waitcnt vmcnt(4)
    s_branch gm_ck28
gm_rt33:
    s_add_u32 s92, s92, 1
    s_cmp_ge_u32 s92, 100000
    s_cbranch_scc1 gm_ok32
    s_add_u32 s39, s85, 110592
    buffer_load_dwordx4 v[164:167], v18, s[56:59], s39 offen offset:0 sc1
    buffer_load_dwordx4 v[168:171], v18, s[56:59], s39 offen offset:1024 sc1
    buffer_load_dwordx4 v[172:175], v18, s[56:59], s39 offen offset:2048 sc1
    buffer_load_dwordx4 v[176:179], v18, s[56:59], s39 offen offset:3072 sc1
    s_add_u32 s39, s91, 0
    buffer_load_dwordx4 v[180:183], v18, s[56:59], s39 offen offset:0 sc1
    buffer_load_dwordx4 v[184:187], v18, s[56:59], s39 offen offset:1024 sc1
    buffer_load_dwordx4 v[188:191], v18, s[56:59], s39 offen offset:2048 sc1
    buffer_load_dwordx4 v[208:211], v18, s[56:59], s39 offen offset:3072 sc1
    s_waitcnt vmcnt(4)
    s_branch gm_ck31
gm_rt36:
    s_add_u32 s92, s92, 1
    s_cmp_ge_u32 s92, 100000
    s_cbranch_scc1 gm_ok35
    s_add_u32 s39, s91, 0
    buffer_load_dwordx4 v[180:183], v18, s[56:59], s39 offen offset:0 sc1
    buffer_load_dwordx4 v[184:187], v18, s[56:59], s39 offen offset:1024 sc1
    buffer_load_dwordx4 v[188:191], v18, s[56:59], s39 offen offset:2048 sc1
    buffer_load_dwordx4 v[208:211], v18, s[56:59], s39 offen offset:3072 sc1
    s_add_u32 s39, s3, 4096
    buffer_load_dwordx4 v[96:99], v18, s[56:59], s39 offen offset:0 sc1
    buffer_load_dwordx4 v[128:131], v18, s[56:59], s39 offen offset:1024 sc1
    buffer_load_dwordx4 v[132:135], v18, s[56:59], s39 offen offset:2048 sc1
    buffer_load_dwordx4 v[160:163], v18, s[56:59], s39 offen offset:3072 sc1
    s_waitcnt vmcnt(4)
    s_branch gm_ck34
gm_rt39:
    s_add_u32 s92, s92, 1
    s_cmp_ge_u32 s92, 100000
    s_cbranch_scc1 gm_ok38
    s_add_u32 s39, s3, 4096
    buffer_load_dwordx4 v[96:99], v18, s[56:59], s39 offen offset:0 sc1
    buffer_load_dwordx4 v[128:131], v18, s[56:59], s39 offen offset:1024 sc1
    buffer_load_dwordx4 v[132:135], v18, s[56:59], s39 offen offset:2048 sc1
    buffer_load_dwordx4 v[160:163], v18, s[56:59], s39 offen offset:3072 sc1
    s_add_u32 s39, s91, 98304
    buffer_load_dwordx4 v[164:167], v18, s[56:59], s39 offen offset:0 sc1
    buffer_load_dwordx4 v[168:171], v18, s[56:59], s39 offen offset:1024 sc1
    buffer_load_dwordx4 v[172:175], v18, s[56:59], s39 offen offset:2048 sc1
    buffer_load_dwordx4 v[176:179], v18, s[56:59], s39 offen offset:3072 sc1
    s_waitcnt vmcnt(4)
    s_branch gm_ck37
gm_rt42:
    s_add_u32 s92, s92, 1
    s_cmp_ge_u32 s92, 100000
    s_cbranch_scc1 gm_ok41
    s_lshr_b32 s88, s95, 6
    s_lshl_b32 s88, s88, 8
    s_lshl_b32 s89, s80, 5
    s_add_u32 s88, s88, s89
    s_add_u32 s88, s88, 720896
    buffer_load_dword v10, v9, s[56:59], s88 offen offset:0 sc1
    buffer_load_dword v11, v9, s[56:59], s88 offen offset:16 sc1
    buffer_load_dword v12, v9, s[56:59], s88 offen offset:128 sc1
    buffer_load_dword v14, v9, s[56:59], s88 offen offset:144 sc1
    s_waitcnt vmcnt(0)
    s_branch gm_ck40
gm_rt45:
    s_add_u32 s92, s92, 1
    s_cmp_ge_u32 s92, 100000
    s_cbranch_scc1 gm_ok44
    s_add_u32 s39, s91, 98304
    buffer_load_dwordx4 v[164:167], v18, s[56:59], s39 offen offset:0 sc1
    buffer_load_dwordx4 v[168:171], v18, s[56:59], s39 offen offset:1024 sc1
    buffer_load_dwordx4 v[172:175], v18, s[56:59], s39 offen offset:2048 sc1
    buffer_load_dwordx4 v[176:179], v18, s[56:59], s39 offen offset:3072 sc1
    s_add_u32 s39, s3, 102400
    buffer_load_dwordx4 v[180:183], v18, s[56:59], s39 offen offset:0 sc1
    buffer_load_dwordx4 v[184:187], v18, s[56:59], s39 offen offset:1024 sc1
    buffer_load_dwordx4 v[188:191], v18, s[56:59], s39 offen offset:2048 sc1
    buffer_load_dwordx4 v[208:211], v18, s[56:59], s39 offen offset:3072 sc1
    s_waitcnt vmcnt(4)
    s_branch gm_ck43
gm_rt48:
    s_add_u32 s92, s92, 1
    s_cmp_ge_u32 s92, 100000
    s_cbranch_scc1 gm_ok47
    s_add_u32 s39, s3, 102400
    buffer_load_dwordx4 v[180:183], v18, s[56:59], s39 offen offset:0 sc1
    buffer_load_dwordx4 v[184:187], v18, s[56:59], s39 offen offset:1024 sc1
    buffer_load_dwordx4 v[188:191], v18, s[56:59], s39 offen offset:2048 sc1
    buffer_load_dwordx4 v[208:211], v18, s[56:59], s39 offen offset:3072 sc1
    s_waitcnt vmcnt(0)
    s_branch gm_ck46
gm_PATHB:
    s_mov_b32 s68, s24
    s_and_b32 s69, s25, 0xffff
    s_mov_b32 s70, 524288
    s_mov_b32 s71, 0x20000
    v_mov_b32 v24, -1
    v_mov_b32 v25, -1
    v_mov_b32 v26, -1
    v_mov_b32 v27, -1
    s_lshl_b32 s38, s81, 2
    s_add_u32 s38, s38, s80
    s_mul_i32 s38, s38, 98304
    s_add_u32 s24, s38, 2097152
    s_lshl_b32 s89, s82, 12
    s_add_u32 s89, s89, s24
    s_add_u32 s89, s89, 67584
    s_lshr_b32 s88, s2, 3
    s_add_u32 s88, s88, s80
    s_and_b32 s88, s88, 7
    s_lshl_b32 s88, s88, 10
    s_lshl_b32 s87, s82, 13
    s_add_u32 s87, s87, s24
    s_lshl_b32 s38, s82, 4
    s_add_u32 s38, s38, s81
    s_lshl_b32 s38, s38, 9
    s_add_u32 s38, s38, 654848
    s_cmp_eq_u32 s80, 3
    s_cselect_b32 s25, s38, 2147418112
    v_cmp_lt_u32 vcc, 31, v0
    v_mov_b32 v23, 2147418112
    s_nop 0
    v_cndmask_b32 v29, v23, v18, vcc
    s_lshl_b32 s38, s2, 2
    s_add_u32 s38, s38, 4096
    s_cmp_eq_u32 s80, 0
    s_cselect_b32 s26, s38, 2147418112
    s_mov_b32 s44, s6
    s_and_b32 s45, s7, 0xffff
    s_mov_b32 s46, 1572864
    s_mov_b32 s47, 0x20000
    s_mov_b32 s60, s10
    s_and_b32 s61, s11, 0xffff
    s_mov_b32 s62, 524288
    s_mov_b32 s63, 0x20000
    s_mov_b32 s64, s22
    s_and_b32 s65, s23, 0xffff
    s_mov_b32 s66, 524288
    s_mov_b32 s67, 0x20000
    s_lshl_b32 s36, s94, 10
    s_lshl_b32 s38, s80, 8
    s_add_u32 s36, s36, s38
    s_lshl_b32 s37, s80, 17
    s_lshl_b32 s38, s94, 1
    s_add_u32 s37, s37, s38
    s_lshl_b32 s32, s85, 7
    s_add_u32 s32, s32, s90
    s_add_u32 m0, s31, 32768
    s_mul_i32 s33, s85, s3
    buffer_load_dwordx4 v9, s[40:43], s32 offen offset:0 lds
    buffer_load_dwordx4 v10, s[40:43], s32 offen offset:1024 lds
    buffer_load_dwordx4 v11, s[40:43], s32 offen offset:2048 lds
    buffer_load_dwordx4 v12, s[40:43], s32 offen offset:3072 lds
    v_bfe_u32 v23, v5, 2, 1
    v_lshlrev_b32 v30, 4, v23
    v_and_b32 v23, 1, v5
    v_lshl_or_b32 v30, v23, 3, v30
    v_lshrrev_b32 v23, 3, v5
    v_lshl_or_b32 v30, v23, 1, v30
    v_bfe_u32 v23, v5, 1, 1
    v_or_b32 v30, v30, v23
    v_bfe_u32 v23, v30, 1, 3
    v_xor_b32 v23, v23, v6
    v_lshlrev_b32 v23, 4, v23
    v_lshl_add_u32 v31, v30, 7, v23
    s_lshl_b32 s38, s80, 12
    v_add_u32 v31, s38, v31
    v_xor_b32 v32, 32, v31
    v_xor_b32 v33, 64, v31
    v_xor_b32 v34, 96, v31
    v_bfe_u32 v23, v5, 1, 3
    v_xor_b32 v23, v23, v6
    v_lshlrev_b32 v23, 4, v23
    v_lshl_add_u32 v35, v5, 7, v23
    v_and_b32 v36, 0x13, v5
    v_bfe_u32 v23, v5, 2, 1
    v_lshl_or_b32 v36, v23, 3, v36
    v_bfe_u32 v23, v5, 3, 1
    v_lshl_or_b32 v36, v23, 2, v36
    v_lshrrev_b32 v38, 2, v8
    v_and_b32 v39, 3, v0
    v_lshrrev_b32 v23, 1, v39
    v_and_b32 v28, 1, v39
    v_lshl_or_b32 v40, v28, 1, v23
    v_and_b32 v23, 1, v7
    v_lshlrev_b32 v23, 5, v23
    v_lshl_add_u32 v23, v39, 3, v23
    v_lshrrev_b32 v28, 1, v38
    v_lshlrev_b32 v28, 6, v28
    v_xor_b32 v23, v23, v28
    v_lshl_add_u32 v28, v6, 3, v38
    v_lshl_add_u32 v37, v28, 7, v23
    v_bfe_u32 v23, v36, 1, 3
    v_xor_b32 v23, v23, v6
    v_lshlrev_b32 v23, 4, v23
    v_lshl_add_u32 v41, v36, 7, v23
    v_xor_b32 v42, 32, v41
    v_xor_b32 v43, 64, v41
    v_xor_b32 v44, 96, v41
    v_xor_b32 v45, 0x10000, v31
    v_xor_b32 v46, 0x10000, v32
    v_xor_b32 v47, 0x10000, v33
    v_xor_b32 v48, 0x10000, v34
    v_xor_b32 v49, 0x10000, v41
    v_xor_b32 v50, 0x10000, v42
    v_xor_b32 v51, 0x10000, v43
    v_xor_b32 v52, 0x10000, v44
    v_bfe_u32 v23, v8, 2, 1
    v_and_b32 v28, 1, v7
    v_cmp_eq_u32 vcc, v23, v28
    s_lshl_b32 s38, s83, 7
    s_add_u32 s38, s38, 155648
    v_lshlrev_b32 v23, 4, v6
    v_lshl_add_u32 v23, v39, 5, v23
    v_add_u32 v23, s38, v23
    v_mov_b32 v28, 157760
    v_cndmask_b32 v53, v28, v23, vcc
    v_mov_b32 v54, 0
    v_mov_b32 v55, 0
    s_lshl_b32 s38, s80, 9
    s_add_u32 s38, s38, 157696
    v_lshlrev_b32 v23, 3, v0
    v_add_u32 v23, s38, v23
    ds_write_b64 v23, v[54:55]
    v_lshl_add_u32 v28, v6, 3, v38
    v_and_b32 v23, 1, v7
    v_lshlrev_b32 v23, 5, v23
    v_lshl_add_u32 v23, v39, 3, v23
    v_lshl_add_u32 v54, v28, 6, v23
    v_lshl_add_u32 v55, v1, 10, v2
    v_lshrrev_b32 v23, 2, v0
    s_lshl_b32 s38, s80, 4
    v_add_u32 v23, s38, v23
    v_mul_u32_u24 v23, 3072, v23
    v_and_b32 v28, 3, v0
    v_lshl_add_u32 v23, v28, 4, v23
    s_lshl_b32 s38, s82, 7
    s_lshl_b32 s39, s93, 6
    s_add_u32 s38, s38, s39
    v_add_u32 v23, s38, v23
    v_cmp_eq_u32 vcc, 0, v0
    v_mov_b32 v28, 2147418112
    s_nop 0
    v_cndmask_b32 v61, v28, v0, vcc
    v_lshl_add_u32 v28, v6, 2, v38
    v_lshlrev_b32 v28, 5, v28
    v_and_b32 v60, 1, v7
    v_lshl_add_u32 v28, v60, 4, v28
    v_lshrrev_b32 v60, 1, v39
    v_lshl_add_u32 v28, v60, 3, v28
    v_add_u32 v63, 159744, v28
    v_bfe_u32 v64, v5, 2, 1
    v_mul_u32_u24 v64, 0x8000, v64
    v_lshl_or_b32 v64, v64, 16, v64
    v_and_b32 v28, 1, v0
    v_lshlrev_b32 v28, 4, v28
    v_mov_b32 v60, 0x3f80
    v_lshlrev_b32 v28, v28, v60
    v_lshrrev_b32 v60, 3, v0
    v_xor_b32 v60, v60, v7
    v_and_b32 v60, 1, v60
    v_lshlrev_b32 v60, 2, v60
    v_bfe_u32 v68, v0, 1, 2
    v_or_b32 v60, v60, v68
    v_cmp_eq_u32 vcc, 0, v60
    s_nop 1
    v_cndmask_b32 v68, 0, v28, vcc
    v_cmp_eq_u32 vcc, 1, v60
    s_nop 1
    v_cndmask_b32 v69, 0, v28, vcc
    v_cmp_eq_u32 vcc, 2, v60
    s_nop 1
    v_cndmask_b32 v70, 0, v28, vcc
    v_cmp_eq_u32 vcc, 3, v60
    s_nop 1
    v_cndmask_b32 v71, 0, v28, vcc
    s_lshl_b32 s38, s80, 5
    v_lshl_add_u32 v100, v6, 4, s38
    v_cvt_f32_u32 v100, v100
    s_lshl_b32 s38, s80, 8
    s_sub_u32 s38, 1792, s38
    v_lshlrev_b32 v101, 10, v6
    v_sub_u32 v101, s38, v101
    v_cvt_f32_u32 v101, v101
    s_waitcnt vmcnt(15)
    v_lshlrev_b32 v4, 16, v4
    s_waitcnt vmcnt(13)
    v_lshlrev_b32 v16, 16, v16
    s_waitcnt vmcnt(11)
    v_lshlrev_b32 v19, 16, v19
    v_mul_f32 v19, 1069066811, v19
    v_exp_f32 v19, v19
    s_nop 0
    v_cvt_pk_bf16_f32 v19, v19, v19
    v_and_b32 v19, 0xffff0000, v19
    v_mul_f32 v28, v19, v4
    v_mul_f32 v28, 1069066811, v28
    v_mul_f32 v60, v19, v16
    v_mul_f32 v60, 0x3E22F983, v60
    v_mul_f32 v65, 1.0, v28
    v_mul_f32 v98, 1.0, v60
    v_exp_f32 v65, v65
    v_rndne_f32 v99, v98
    v_sub_f32 v98, v98, v99
    v_cos_f32 v99, v98
    v_sin_f32 v98, v98
    v_mul_f32 v66, v65, v99
    v_mul_f32 v72, v65, v98
    v_mul_f32 v65, 1090519040, v28
    v_mul_f32 v98, 1090519040, v60
    v_exp_f32 v65, v65
    v_rndne_f32 v99, v98
    v_sub_f32 v98, v98, v99
    v_cos_f32 v99, v98
    v_sin_f32 v98, v98
    v_mul_f32 v74, v65, v99
    v_mul_f32 v76, v65, v98
    v_mul_f32 v65, 1098907648, v28
    v_mul_f32 v98, 1098907648, v60
    v_exp_f32 v65, v65
    v_rndne_f32 v99, v98
    v_sub_f32 v98, v98, v99
    v_cos_f32 v99, v98
    v_sin_f32 v98, v98
    v_mul_f32 v78, v65, v99
    v_mul_f32 v80, v65, v98
    v_mul_f32 v65, v100, v28
    v_mul_f32 v98, v100, v60
    v_exp_f32 v65, v65
    v_rndne_f32 v99, v98
    v_sub_f32 v98, v98, v99
    v_cos_f32 v99, v98
    v_sin_f32 v98, v98
    v_mul_f32 v82, v65, v99
    v_mul_f32 v84, v65, v98
    v_mul_f32 v65, 1124073472, v28
    v_mul_f32 v98, 1124073472, v60
    v_exp_f32 v65, v65
    v_rndne_f32 v99, v98
    v_sub_f32 v98, v98, v99
    v_cos_f32 v99, v98
    v_sin_f32 v98, v98
    v_mul_f32 v86, v65, v99
    v_mul_f32 v88, v65, v98
    v_mul_f32 v65, v101, v28
    v_mul_f32 v98, v101, v60
    v_exp_f32 v65, v65
    v_rndne_f32 v99, v98
    v_sub_f32 v98, v98, v99
    v_cos_f32 v99, v98
    v_sin_f32 v98, v98
    v_mul_f32 v90, v65, v99
    v_mul_f32 v92, v65, v98
    v_add_f32 v65, -1.0, v66
    v_mul_f32 v98, v4, v4
    v_fmac_f32 v98, v16, v16
    v_rcp_f32 v98, v98
    v_mul_f32 v94, v65, v4
    v_fmac_f32 v94, v72, v16
    v_mul_f32 v96, v72, v4
    v_fma_f32 v96, -v65, v16, v96
    v_mul_f32 v94, v94, v98
    v_mul_f32 v96, v96, v98
    s_add_u32 m0, s34, 49152
    s_add_u32 s33, s33, s91
    buffer_load_dwordx4 v14, s[48:51], s33 offen offset:0 lds
    buffer_load_dwordx4 v15, s[48:51], s33 offen offset:1024 lds
    v_lshlrev_b32 v20, 16, v20
    v_lshlrev_b32 v21, 16, v21
    s_waitcnt vmcnt(12)
    v_lshlrev_b32 v22, 16, v22
    v_mul_f32 v22, 1069066811, v22
    v_exp_f32 v22, v22
    s_nop 0
    v_cvt_pk_bf16_f32 v22, v22, v22
    v_and_b32 v22, 0xffff0000, v22
    v_mul_f32 v28, v22, v20
    v_mul_f32 v28, 1069066811, v28
    v_mul_f32 v60, v22, v21
    v_mul_f32 v60, 0x3E22F983, v60
    v_mul_f32 v65, 1.0, v28
    v_mul_f32 v98, 1.0, v60
    v_exp_f32 v65, v65
    v_rndne_f32 v99, v98
    v_sub_f32 v98, v98, v99
    v_cos_f32 v99, v98
    v_sin_f32 v98, v98
    v_mul_f32 v67, v65, v99
    v_mul_f32 v73, v65, v98
    v_mul_f32 v65, 1090519040, v28
    v_mul_f32 v98, 1090519040, v60
    v_exp_f32 v65, v65
    v_rndne_f32 v99, v98
    v_sub_f32 v98, v98, v99
    v_cos_f32 v99, v98
    v_sin_f32 v98, v98
    v_mul_f32 v75, v65, v99
    v_mul_f32 v77, v65, v98
    v_mul_f32 v65, 1098907648, v28
    v_mul_f32 v98, 1098907648, v60
    v_exp_f32 v65, v65
    v_rndne_f32 v99, v98
    v_sub_f32 v98, v98, v99
    v_cos_f32 v99, v98
    v_sin_f32 v98, v98
    v_mul_f32 v79, v65, v99
    v_mul_f32 v81, v65, v98
    v_mul_f32 v65, v100, v28
    v_mul_f32 v98, v100, v60
    v_exp_f32 v65, v65
    v_rndne_f32 v99, v98
    v_sub_f32 v98, v98, v99
    v_cos_f32 v99, v98
    v_sin_f32 v98, v98
    v_mul_f32 v83, v65, v99
    v_mul_f32 v85, v65, v98
    v_mul_f32 v65, 1124073472, v28
    v_mul_f32 v98, 1124073472, v60
    v_exp_f32 v65, v65
    v_rndne_f32 v99, v98
    v_sub_f32 v98, v98, v99
    v_cos_f32 v99, v98
    v_sin_f32 v98, v98
    v_mul_f32 v87, v65, v99
    v_mul_f32 v89, v65, v98
    v_mul_f32 v65, v101, v28
    v_mul_f32 v98, v101, v60
    v_exp_f32 v65, v65
    v_rndne_f32 v99, v98
    v_sub_f32 v98, v98, v99
    v_cos_f32 v99, v98
    v_sin_f32 v98, v98
    v_mul_f32 v91, v65, v99
    v_mul_f32 v93, v65, v98
    v_add_f32 v65, -1.0, v67
    v_mul_f32 v98, v20, v20
    v_fmac_f32 v98, v21, v21
    v_rcp_f32 v98, v98
    v_mul_f32 v95, v65, v20
    v_fmac_f32 v95, v73, v21
    v_mul_f32 v97, v73, v20
    v_fma_f32 v97, -v65, v21, v97
    v_mul_f32 v95, v95, v98
    v_mul_f32 v97, v97, v98
    s_add_u32 m0, s34, 57344
    s_add_u32 s33, s33, s30
    buffer_load_dwordx4 v14, s[52:55], s33 offen offset:0 lds
    buffer_load_dwordx4 v15, s[52:55], s33 offen offset:1024 lds
    s_add_u32 s85, s85, 1
    s_and_b32 s85, s85, 7
    v_pk_mul_f32 v[20:21], v[82:83], v[96:97]
    v_pk_mul_f32 v[82:83], v[82:83], v[94:95]
    v_pk_fma_f32 v[82:83], v[84:85], v[96:97], v[82:83] neg_lo:[1,0,0] neg_hi:[1,0,0]
    v_pk_fma_f32 v[84:85], v[84:85], v[94:95], v[20:21]
    v_mov_b32 v100, 0
    v_mov_b32 v101, 0
    v_mov_b32 v102, 0
    v_mov_b32 v103, 0
    s_lshl_b32 s38, s80, 10
    s_add_u32 s38, s38, 131072
    v_add_u32 v4, s38, v18
    ds_write_b128 v4, v[100:103]
    s_lshl_b32 s38, s80, 10
    s_add_u32 s39, s38, 131584
    v_add_u32 v4, s39, v18
    s_add_u32 s39, s38, 147456
    v_add_u32 v16, s39, v18
    v_lshlrev_b32 v19, 4, v5
    v_lshl_add_u32 v20, v6, 12, v19
    v_add_u32 v19, 147456, v19
    s_sub_u32 s39, s81, 16
    s_lshl_b32 s39, s39, 9
    s_add_u32 s39, s39, s38
    v_add_u32 v20, s39, v20
    v_add_u32 v21, 512, v20
    buffer_store_dwordx4 v[24:27], v29, s[56:59], s25 offen sc1
    s_waitcnt vmcnt(10) lgkmcnt(0)
    s_barrier
    ds_read_b128 a[0:3], v31 offset:0
    ds_read_b128 v[180:183], v41 offset:16384
    ds_read_b128 v[184:187], v41 offset:20480
    ds_read_b128 v[188:191], v41 offset:24576
    ds_read_b128 v[192:195], v41 offset:28672
    ds_read_b128 v[212:215], v53 offset:0
    ds_read_b128 a[4:7], v32 offset:0
    s_waitcnt lgkmcnt(5)
    v_mfma_f32_32x32x16_bf16 v[100:115], a[0:3], v[180:183], 0
    s_lshl_b32 s32, s85, 7
    s_add_u32 s32, s32, s90
    s_add_u32 m0, s31, 65536
    s_mul_i32 s33, s85, s3
    buffer_load_dwordx4 v9, s[40:43], s32 offen offset:0 lds
    ds_read_b128 v[196:199], v42 offset:16384
    s_waitcnt lgkmcnt(5)
    v_mfma_f32_32x32x16_bf16 v[116:131], a[0:3], v[184:187], 0
    ds_read_b128 v[200:203], v42 offset:20480
    s_waitcnt lgkmcnt(5)
    v_mfma_f32_32x32x16_bf16 v[132:147], a[0:3], v[188:191], 0
    buffer_load_dwordx4 v10, s[40:43], s32 offen offset:1024 lds
    ds_read_b128 v[204:207], v42 offset:24576
    s_waitcnt lgkmcnt(5)
    v_mfma_f32_32x32x16_bf16 v[148:163], a[0:3], v[192:195], 0
    ds_read_b128 v[208:211], v42 offset:28672
    s_waitcnt lgkmcnt(5)
    v_mfma_f32_16x16x32_bf16 v[164:167], v[212:215], a[0:3], 0
    ds_read_b128 a[8:11], v33 offset:0
    s_waitcnt lgkmcnt(4)
    v_mfma_f32_32x32x16_bf16 v[100:115], a[4:7], v[196:199], v[100:115]
    buffer_load_dwordx4 v11, s[40:43], s32 offen offset:2048 lds
    ds_read_b128 v[180:183], v43 offset:16384
    s_waitcnt lgkmcnt(4)
    v_mfma_f32_32x32x16_bf16 v[116:131], a[4:7], v[200:203], v[116:131]
    ds_read_b128 v[184:187], v43 offset:20480
    s_waitcnt lgkmcnt(4)
    v_mfma_f32_32x32x16_bf16 v[132:147], a[4:7], v[204:207], v[132:147]
    buffer_load_dwordx4 v12, s[40:43], s32 offen offset:3072 lds
    ds_read_b128 v[188:191], v43 offset:24576
    s_waitcnt lgkmcnt(4)
    v_mfma_f32_32x32x16_bf16 v[148:163], a[4:7], v[208:211], v[148:163]
    ds_read_b128 v[192:195], v43 offset:28672
    v_mfma_f32_16x16x32_bf16 v[168:171], v[212:215], a[4:7], 0
    ds_read_b128 a[12:15], v34 offset:0
    s_waitcnt lgkmcnt(4)
    v_mfma_f32_32x32x16_bf16 v[100:115], a[8:11], v[180:183], v[100:115]
    s_add_u32 m0, s34, 81920
    s_add_u32 s33, s33, s91
    buffer_load_dwordx4 v14, s[48:51], s33 offen offset:0 lds
    ds_read_b128 v[196:199], v44 offset:16384
    s_waitcnt lgkmcnt(4)
    v_mfma_f32_32x32x16_bf16 v[116:131], a[8:11], v[184:187], v[116:131]
    ds_read_b128 v[200:203], v44 offset:20480
    s_waitcnt lgkmcnt(4)
    v_mfma_f32_32x32x16_bf16 v[132:147], a[8:11], v[188:191], v[132:147]
    buffer_load_dwordx4 v15, s[48:51], s33 offen offset:1024 lds
    ds_read_b128 v[204:207], v44 offset:24576
    s_waitcnt lgkmcnt(4)
    v_mfma_f32_32x32x16_bf16 v[148:163], a[8:11], v[192:195], v[148:163]
    ds_read_b128 v[208:211], v44 offset:28672
    v_mfma_f32_16x16x32_bf16 v[172:175], v[212:215], a[8:11], 0
    s_waitcnt lgkmcnt(3)
    v_mfma_f32_32x32x16_bf16 v[100:115], a[12:15], v[196:199], v[100:115]
    ds_read_b64_tr_b16 v[220:221], v63 offset:1024
    ds_read_b64_tr_b16 v[222:223], v63 offset:1280
    ds_read_b64_tr_b16 v[224:225], v63 offset:1536
    ds_read_b64_tr_b16 v[226:227], v63 offset:1792
    s_waitcnt vmcnt(15)
    v_readfirstlane_b32 s84, v17
    s_nop 0
    s_mul_i32 s84, s84, 0x9E3779B1
    s_add_u32 s84, s84, 0x7F4A7C15
    v_mov_b32 v17, s84
    s_mov_b32 s0, s84
    s_mov_b32 s1, s84
    s_waitcnt lgkmcnt(3)
    v_xor_b32 v220, v220, v64
    v_xor_b32 v221, v221, v64
    s_waitcnt lgkmcnt(2)
    v_xor_b32 v222, v222, v64
    v_xor_b32 v223, v223, v64
    s_waitcnt lgkmcnt(1)
    v_xor_b32 v224, v224, v64
    v_xor_b32 v225, v225, v64
    s_waitcnt lgkmcnt(0)
    v_xor_b32 v226, v226, v64
    v_xor_b32 v227, v227, v64
    s_waitcnt vmcnt(7)
    s_barrier
    ds_read_b128 a[16:19], v31 offset:32768
    ds_read_b128 v[180:183], v41 offset:49152
    v_mfma_f32_32x32x16_bf16 v[116:131], a[12:15], v[200:203], v[116:131]
    ds_read_b128 v[184:187], v41 offset:53248
    ds_read_b128 v[188:191], v41 offset:57344
    v_mfma_f32_32x32x16_bf16 v[132:147], a[12:15], v[204:207], v[132:147]
    s_add_u32 m0, s34, 90112
    s_add_u32 s33, s33, s30
    buffer_load_dwordx4 v14, s[52:55], s33 offen offset:0 lds
    ds_read_b128 v[192:195], v41 offset:61440
    ds_read_b128 v[216:219], v53 offset:128
    v_mfma_f32_32x32x16_bf16 v[148:163], a[12:15], v[208:211], v[148:163]
    buffer_load_dwordx4 v15, s[52:55], s33 offen offset:1024 lds
    s_add_u32 s85, s85, 1
    s_and_b32 s85, s85, 7
    v_mfma_f32_16x16x32_bf16 v[176:179], v[212:215], a[12:15], 0
    ds_read_b128 a[20:23], v32 offset:32768
    s_waitcnt lgkmcnt(5)
    v_mfma_f32_32x32x16_bf16 v[100:115], a[16:19], v[180:183], v[100:115]
    s_xor_b32 s39, s88, 0
    s_add_u32 s39, s39, s87
    buffer_store_dwordx4 v[24:27], v18, s[56:59], s39 offen sc1
    s_lshl_b32 s32, s85, 7
    s_add_u32 s32, s32, s90
    s_add_u32 m0, s31, 98304
    s_mul_i32 s33, s85, s3
    buffer_load_dwordx4 v9, s[40:43], s32 offen offset:0 lds
    ds_read_b128 v[196:199], v42 offset:49152
    s_waitcnt lgkmcnt(5)
    v_mfma_f32_32x32x16_bf16 v[116:131], a[16:19], v[184:187], v[116:131]
    ds_read_b128 v[200:203], v42 offset:53248
    s_waitcnt lgkmcnt(5)
    v_mfma_f32_32x32x16_bf16 v[132:147], a[16:19], v[188:191], v[132:147]
    buffer_load_dwordx4 v10, s[40:43], s32 offen offset:1024 lds
    ds_read_b128 v[204:207], v42 offset:57344
    s_waitcnt lgkmcnt(5)
    v_mfma_f32_32x32x16_bf16 v[148:163], a[16:19], v[192:195], v[148:163]
    ds_read_b128 v[208:211], v42 offset:61440
    s_waitcnt lgkmcnt(5)
    v_mfma_f32_16x16x32_bf16 v[164:167], v[216:219], a[16:19], v[164:167]
    ds_read_b128 a[24:27], v33 offset:32768
    s_waitcnt lgkmcnt(4)
    v_mfma_f32_32x32x16_bf16 v[100:115], a[20:23], v[196:199], v[100:115]
    s_xor_b32 s39, s88, 1024
    s_add_u32 s39, s39, s87
    buffer_store_dwordx4 v[24:27], v18, s[56:59], s39 offen sc1
    buffer_load_dwordx4 v11, s[40:43], s32 offen offset:2048 lds
    ds_read_b128 v[180:183], v43 offset:49152
    s_waitcnt lgkmcnt(4)
    v_mfma_f32_32x32x16_bf16 v[116:131], a[20:23], v[200:203], v[116:131]
    ds_read_b128 v[184:187], v43 offset:53248
    s_waitcnt lgkmcnt(4)
    v_mfma_f32_32x32x16_bf16 v[132:147], a[20:23], v[204:207], v[132:147]
    buffer_load_dwordx4 v12, s[40:43], s32 offen offset:3072 lds
    ds_read_b128 v[188:191], v43 offset:57344
    s_waitcnt lgkmcnt(4)
    v_mfma_f32_32x32x16_bf16 v[148:163], a[20:23], v[208:211], v[148:163]
    ds_read_b128 v[192:195], v43 offset:61440
    v_mfma_f32_16x16x32_bf16 v[168:171], v[216:219], a[20:23], v[168:171]
    ds_read_b128 a[28:31], v34 offset:32768
    s_waitcnt lgkmcnt(4)
    v_mfma_f32_32x32x16_bf16 v[100:115], a[24:27], v[180:183], v[100:115]
    s_add_u32 m0, s34, 114688
    s_add_u32 s33, s33, s91
    buffer_load_dwordx4 v14, s[48:51], s33 offen offset:0 lds
    ds_read_b128 v[196:199], v44 offset:49152
    s_waitcnt lgkmcnt(4)
    v_mfma_f32_32x32x16_bf16 v[116:131], a[24:27], v[184:187], v[116:131]
    ds_read_b128 v[200:203], v44 offset:53248
    s_waitcnt lgkmcnt(4)
    v_mfma_f32_32x32x16_bf16 v[132:147], a[24:27], v[188:191], v[132:147]
    buffer_load_dwordx4 v15, s[48:51], s33 offen offset:1024 lds
    ds_read_b128 v[204:207], v44 offset:57344
    s_waitcnt lgkmcnt(4)
    v_mfma_f32_32x32x16_bf16 v[148:163], a[24:27], v[192:195], v[148:163]
    ds_read_b128 v[208:211], v44 offset:61440
    v_mfma_f32_16x16x32_bf16 v[172:175], v[216:219], a[24:27], v[172:175]
    s_waitcnt lgkmcnt(3)
    v_mfma_f32_32x32x16_bf16 v[100:115], a[28:31], v[196:199], v[100:115]
    s_waitcnt vmcnt(8)
    s_barrier
    buffer_store_dword v17, v61, s[56:59], s26 offen sc1
    ds_read_b128 a[32:35], v45 offset:0
    ds_read_b128 v[180:183], v49 offset:16384
    s_waitcnt lgkmcnt(4)
    v_mfma_f32_32x32x16_bf16 v[116:131], a[28:31], v[200:203], v[116:131]
    ds_read_b128 v[184:187], v49 offset:20480
    ds_read_b128 v[188:191], v49 offset:24576
    s_waitcnt lgkmcnt(5)
    v_mfma_f32_32x32x16_bf16 v[132:147], a[28:31], v[204:207], v[132:147]
    s_add_u32 m0, s34, 122880
    s_add_u32 s33, s33, s30
    buffer_load_dwordx4 v14, s[52:55], s33 offen offset:0 lds
    ds_read_b128 v[192:195], v49 offset:28672
    ds_read_b128 v[212:215], v53 offset:256
    s_waitcnt lgkmcnt(6)
    v_mfma_f32_32x32x16_bf16 v[148:163], a[28:31], v[208:211], v[148:163]
    buffer_load_dwordx4 v15, s[52:55], s33 offen offset:1024 lds
    s_add_u32 s85, s85, 1
    s_and_b32 s85, s85, 7
    v_mfma_f32_16x16x32_bf16 v[176:179], v[216:219], a[28:31], v[176:179]
    ds_read_b128 a[36:39], v46 offset:0
    s_waitcnt lgkmcnt(5)
    v_mfma_f32_32x32x16_bf16 v[100:115], a[32:35], v[180:183], v[100:115]
    s_xor_b32 s39, s88, 2048
    s_add_u32 s39, s39, s87
    buffer_store_dwordx4 v[24:27], v18, s[56:59], s39 offen sc1
    s_lshl_b32 s32, s85, 7
    s_add_u32 s32, s32, s90
    s_add_u32 m0, s31, 0
    s_mul_i32 s33, s85, s3
    buffer_load_dwordx4 v9, s[40:43], s32 offen offset:0 lds
    ds_read_b128 v[196:199], v50 offset:16384
    s_waitcnt lgkmcnt(5)
    v_mfma_f32_32x32x16_bf16 v[116:131], a[32:35], v[184:187], v[116:131]
    ds_read_b128 v[200:203], v50 offset:20480
    s_waitcnt lgkmcnt(5)
    v_mfma_f32_32x32x16_bf16 v[132:147], a[32:35], v[188:191], v[132:147]
    buffer_load_dwordx4 v10, s[40:43], s32 offen offset:1024 lds
    ds_read_b128 v[204:207], v50 offset:24576
    s_waitcnt lgkmcnt(5)
    v_mfma_f32_32x32x16_bf16 v[148:163], a[32:35], v[192:195], v[148:163]
    ds_read_b128 v[208:211], v50 offset:28672
    s_waitcnt lgkmcnt(5)
    v_mfma_f32_16x16x32_bf16 v[164:167], v[212:215], a[32:35], v[164:167]
    ds_read_b128 a[40:43], v47 offset:0
    s_waitcnt lgkmcnt(4)
    v_mfma_f32_32x32x16_bf16 v[100:115], a[36:39], v[196:199], v[100:115]
    s_xor_b32 s39, s88, 3072
    s_add_u32 s39, s39, s87
    buffer_store_dwordx4 v[24:27], v18, s[56:59], s39 offen sc1
    buffer_load_dwordx4 v11, s[40:43], s32 offen offset:2048 lds
    ds_read_b128 v[180:183], v51 offset:16384
    s_waitcnt lgkmcnt(4)
    v_mfma_f32_32x32x16_bf16 v[116:131], a[36:39], v[200:203], v[116:131]
    ds_read_b128 v[184:187], v51 offset:20480
    s_waitcnt lgkmcnt(4)
    v_mfma_f32_32x32x16_bf16 v[132:147], a[36:39], v[204:207], v[132:147]
    buffer_load_dwordx4 v12, s[40:43], s32 offen offset:3072 lds
    ds_read_b128 v[188:191], v51 offset:24576
    s_waitcnt lgkmcnt(4)
    v_mfma_f32_32x32x16_bf16 v[148:163], a[36:39], v[208:211], v[148:163]
    ds_read_b128 v[192:195], v51 offset:28672
    v_mfma_f32_16x16x32_bf16 v[168:171], v[212:215], a[36:39], v[168:171]
    ds_read_b128 a[44:47], v48 offset:0
    s_waitcnt lgkmcnt(4)
    v_mfma_f32_32x32x16_bf16 v[100:115], a[40:43], v[180:183], v[100:115]
    s_add_u32 m0, s34, 16384
    s_add_u32 s33, s33, s91
    buffer_load_dwordx4 v14, s[48:51], s33 offen offset:0 lds
    ds_read_b128 v[196:199], v52 offset:16384
    s_waitcnt lgkmcnt(4)
    v_mfma_f32_32x32x16_bf16 v[116:131], a[40:43], v[184:187], v[116:131]
    ds_read_b128 v[200:203], v52 offset:20480
    s_waitcnt lgkmcnt(4)
    v_mfma_f32_32x32x16_bf16 v[132:147], a[40:43], v[188:191], v[132:147]
    buffer_load_dwordx4 v15, s[48:51], s33 offen offset:1024 lds
    ds_read_b128 v[204:207], v52 offset:24576
    s_waitcnt lgkmcnt(4)
    v_mfma_f32_32x32x16_bf16 v[148:163], a[40:43], v[192:195], v[148:163]
    ds_read_b128 v[208:211], v52 offset:28672
    v_mfma_f32_16x16x32_bf16 v[172:175], v[212:215], a[40:43], v[172:175]
    s_waitcnt lgkmcnt(3)
    v_mfma_f32_32x32x16_bf16 v[100:115], a[44:47], v[196:199], v[100:115]
    s_waitcnt vmcnt(8)
    s_barrier
    ds_read_b128 a[48:51], v45 offset:32768
    ds_read_b128 v[180:183], v49 offset:49152
    s_waitcnt lgkmcnt(4)
    v_mfma_f32_32x32x16_bf16 v[116:131], a[44:47], v[200:203], v[116:131]
    ds_read_b128 v[184:187], v49 offset:53248
    ds_read_b128 v[188:191], v49 offset:57344
    s_waitcnt lgkmcnt(5)
    v_mfma_f32_32x32x16_bf16 v[132:147], a[44:47], v[204:207], v[132:147]
    s_add_u32 m0, s34, 24576
    s_add_u32 s33, s33, s30
    buffer_load_dwordx4 v14, s[52:55], s33 offen offset:0 lds
    ds_read_b128 v[192:195], v49 offset:61440
    ds_read_b128 v[216:219], v53 offset:384
    s_waitcnt lgkmcnt(6)
    v_mfma_f32_32x32x16_bf16 v[148:163], a[44:47], v[208:211], v[148:163]
    buffer_load_dwordx4 v15, s[52:55], s33 offen offset:1024 lds
    s_add_u32 s85, s85, 1
    s_and_b32 s85, s85, 7
    v_mfma_f32_16x16x32_bf16 v[176:179], v[212:215], a[44:47], v[176:179]
    ds_read_b128 a[52:55], v46 offset:32768
    s_waitcnt lgkmcnt(5)
    v_mfma_f32_32x32x16_bf16 v[100:115], a[48:51], v[180:183], v[100:115]
    s_xor_b32 s39, s88, 4096
    s_add_u32 s39, s39, s87
    buffer_store_dwordx4 v[24:27], v18, s[56:59], s39 offen sc1
    s_lshl_b32 s32, s85, 7
    s_add_u32 s32, s32, s90
    s_add_u32 m0, s31, 32768
    s_mul_i32 s33, s85, s3
    buffer_load_dwordx4 v9, s[40:43], s32 offen offset:0 lds
    ds_read_b128 v[196:199], v50 offset:49152
    s_waitcnt lgkmcnt(5)
    v_mfma_f32_32x32x16_bf16 v[116:131], a[48:51], v[184:187], v[116:131]
    ds_read_b128 v[200:203], v50 offset:53248
    s_waitcnt lgkmcnt(5)
    v_mfma_f32_32x32x16_bf16 v[132:147], a[48:51], v[188:191], v[132:147]
    buffer_load_dwordx4 v10, s[40:43], s32 offen offset:1024 lds
    ds_read_b128 v[204:207], v50 offset:57344
    s_waitcnt lgkmcnt(5)
    v_mfma_f32_32x32x16_bf16 v[148:163], a[48:51], v[192:195], v[148:163]
    ds_read_b128 v[208:211], v50 offset:61440
    s_waitcnt lgkmcnt(5)
    v_mfma_f32_16x16x32_bf16 v[164:167], v[216:219], a[48:51], v[164:167]
    ds_read_b128 a[56:59], v47 offset:32768
    s_waitcnt lgkmcnt(4)
    v_mfma_f32_32x32x16_bf16 v[100:115], a[52:55], v[196:199], v[100:115]
    s_xor_b32 s39, s88, 5120
    s_add_u32 s39, s39, s87
    buffer_store_dwordx4 v[24:27], v18, s[56:59], s39 offen sc1
    buffer_load_dwordx4 v11, s[40:43], s32 offen offset:2048 lds
    ds_read_b128 v[180:183], v51 offset:49152
    s_waitcnt lgkmcnt(4)
    v_mfma_f32_32x32x16_bf16 v[116:131], a[52:55], v[200:203], v[116:131]
    ds_read_b128 v[184:187], v51 offset:53248
    s_waitcnt lgkmcnt(4)
    v_mfma_f32_32x32x16_bf16 v[132:147], a[52:55], v[204:207], v[132:147]
    buffer_load_dwordx4 v12, s[40:43], s32 offen offset:3072 lds
    ds_read_b128 v[188:191], v51 offset:57344
    s_waitcnt lgkmcnt(4)
    v_mfma_f32_32x32x16_bf16 v[148:163], a[52:55], v[208:211], v[148:163]
    ds_read_b128 v[192:195], v51 offset:61440
    v_mfma_f32_16x16x32_bf16 v[168:171], v[216:219], a[52:55], v[168:171]
    ds_read_b128 a[60:63], v48 offset:32768
    s_waitcnt lgkmcnt(4)
    v_mfma_f32_32x32x16_bf16 v[100:115], a[56:59], v[180:183], v[100:115]
    s_add_u32 m0, s34, 49152
    s_add_u32 s33, s33, s91
    buffer_load_dwordx4 v14, s[48:51], s33 offen offset:0 lds
    ds_read_b128 v[196:199], v52 offset:49152
    s_waitcnt lgkmcnt(4)
    v_mfma_f32_32x32x16_bf16 v[116:131], a[56:59], v[184:187], v[116:131]
    ds_read_b128 v[200:203], v52 offset:53248
    s_waitcnt lgkmcnt(4)
    v_mfma_f32_32x32x16_bf16 v[132:147], a[56:59], v[188:191], v[132:147]
    buffer_load_dwordx4 v15, s[48:51], s33 offen offset:1024 lds
    ds_read_b128 v[204:207], v52 offset:57344
    s_waitcnt lgkmcnt(4)
    v_mfma_f32_32x32x16_bf16 v[148:163], a[56:59], v[192:195], v[148:163]
    ds_read_b128 v[208:211], v52 offset:61440
    v_mfma_f32_16x16x32_bf16 v[172:175], v[216:219], a[56:59], v[172:175]
    s_waitcnt lgkmcnt(3)
    v_mfma_f32_32x32x16_bf16 v[100:115], a[60:63], v[196:199], v[100:115]
    s_waitcnt vmcnt(8)
    s_barrier
    ds_read_b128 a[64:67], v31 offset:0
    ds_read_b128 v[180:183], v41 offset:16384
    s_waitcnt lgkmcnt(4)
    v_mfma_f32_32x32x16_bf16 v[116:131], a[60:63], v[200:203], v[116:131]
    ds_read_b128 v[184:187], v41 offset:20480
    ds_read_b128 v[188:191], v41 offset:24576
    s_waitcnt lgkmcnt(5)
    v_mfma_f32_32x32x16_bf16 v[132:147], a[60:63], v[204:207], v[132:147]
    s_add_u32 m0, s34, 57344
    s_add_u32 s33, s33, s30
    buffer_load_dwordx4 v14, s[52:55], s33 offen offset:0 lds
    ds_read_b128 v[192:195], v41 offset:28672
    ds_read_b128 v[212:215], v53 offset:512
    s_waitcnt lgkmcnt(6)
    v_mfma_f32_32x32x16_bf16 v[148:163], a[60:63], v[208:211], v[148:163]
    buffer_load_dwordx4 v15, s[52:55], s33 offen offset:1024 lds
    s_add_u32 s85, s85, 1
    s_and_b32 s85, s85, 7
    v_mfma_f32_16x16x32_bf16 v[176:179], v[216:219], a[60:63], v[176:179]
    ds_read_b128 a[68:71], v32 offset:0
    s_waitcnt lgkmcnt(5)
    v_mfma_f32_32x32x16_bf16 v[100:115], a[64:67], v[180:183], v[100:115]
    s_xor_b32 s39, s88, 6144
    s_add_u32 s39, s39, s87
    buffer_store_dwordx4 v[24:27], v18, s[56:59], s39 offen sc1
    s_lshl_b32 s32, s85, 7
    s_add_u32 s32, s32, s90
    s_add_u32 m0, s31, 65536
    s_mul_i32 s33, s85, s3
    buffer_load_dwordx4 v9, s[40:43], s32 offen offset:0 lds
    ds_read_b128 v[196:199], v42 offset:16384
    s_waitcnt lgkmcnt(5)
    v_mfma_f32_32x32x16_bf16 v[116:131], a[64:67], v[184:187], v[116:131]
    ds_read_b128 v[200:203], v42 offset:20480
    s_waitcnt lgkmcnt(5)
    v_mfma_f32_32x32x16_bf16 v[132:147], a[64:67], v[188:191], v[132:147]
    buffer_load_dwordx4 v10, s[40:43], s32 offen offset:1024 lds
    ds_read_b128 v[204:207], v42 offset:24576
    s_waitcnt lgkmcnt(5)
    v_mfma_f32_32x32x16_bf16 v[148:163], a[64:67], v[192:195], v[148:163]
    ds_read_b128 v[208:211], v42 offset:28672
    s_waitcnt lgkmcnt(5)
    v_mfma_f32_16x16x32_bf16 v[164:167], v[212:215], a[64:67], v[164:167]
    ds_read_b128 a[72:75], v33 offset:0
    s_waitcnt lgkmcnt(4)
    v_mfma_f32_32x32x16_bf16 v[100:115], a[68:71], v[196:199], v[100:115]
    s_xor_b32 s39, s88, 7168
    s_add_u32 s39, s39, s87
    buffer_store_dwordx4 v[24:27], v18, s[56:59], s39 offen sc1
    buffer_load_dwordx4 v11, s[40:43], s32 offen offset:2048 lds
    ds_read_b128 v[180:183], v43 offset:16384
    s_waitcnt lgkmcnt(4)
    v_mfma_f32_32x32x16_bf16 v[116:131], a[68:71], v[200:203], v[116:131]
    ds_read_b128 v[184:187], v43 offset:20480
    s_waitcnt lgkmcnt(4)
    v_mfma_f32_32x32x16_bf16 v[132:147], a[68:71], v[204:207], v[132:147]
    buffer_load_dwordx4 v12, s[40:43], s32 offen offset:3072 lds
    ds_read_b128 v[188:191], v43 offset:24576
    s_waitcnt lgkmcnt(4)
    v_mfma_f32_32x32x16_bf16 v[148:163], a[68:71], v[208:211], v[148:163]
    ds_read_b128 v[192:195], v43 offset:28672
    v_mfma_f32_16x16x32_bf16 v[168:171], v[212:215], a[68:71], v[168:171]
    ds_read_b128 a[76:79], v34 offset:0
    s_waitcnt lgkmcnt(4)
    v_mfma_f32_32x32x16_bf16 v[100:115], a[72:75], v[180:183], v[100:115]
    s_add_u32 m0, s34, 81920
    s_add_u32 s33, s33, s91
    buffer_load_dwordx4 v14, s[48:51], s33 offen offset:0 lds
    ds_read_b128 v[196:199], v44 offset:16384
    s_waitcnt lgkmcnt(4)
    v_mfma_f32_32x32x16_bf16 v[116:131], a[72:75], v[184:187], v[116:131]
    ds_read_b128 v[200:203], v44 offset:20480
    s_waitcnt lgkmcnt(4)
    v_mfma_f32_32x32x16_bf16 v[132:147], a[72:75], v[188:191], v[132:147]
    buffer_load_dwordx4 v15, s[48:51], s33 offen offset:1024 lds
    ds_read_b128 v[204:207], v44 offset:24576
    s_waitcnt lgkmcnt(4)
    v_mfma_f32_32x32x16_bf16 v[148:163], a[72:75], v[192:195], v[148:163]
    ds_read_b128 v[208:211], v44 offset:28672
    v_mfma_f32_16x16x32_bf16 v[172:175], v[212:215], a[72:75], v[172:175]
    s_waitcnt lgkmcnt(3)
    v_mfma_f32_32x32x16_bf16 v[100:115], a[76:79], v[196:199], v[100:115]
    s_waitcnt vmcnt(8)
    s_barrier
    ds_read_b128 a[80:83], v31 offset:32768
    ds_read_b128 v[180:183], v41 offset:49152
    s_waitcnt lgkmcnt(4)
    v_mfma_f32_32x32x16_bf16 v[116:131], a[76:79], v[200:203], v[116:131]
    ds_read_b128 v[184:187], v41 offset:53248
    ds_read_b128 v[188:191], v41 offset:57344
    s_waitcnt lgkmcnt(5)
    v_mfma_f32_32x32x16_bf16 v[132:147], a[76:79], v[204:207], v[132:147]
    s_add_u32 m0, s34, 90112
    s_add_u32 s33, s33, s30
    buffer_load_dwordx4 v14, s[52:55], s33 offen offset:0 lds
    ds_read_b128 v[192:195], v41 offset:61440
    ds_read_b128 v[216:219], v53 offset:640
    s_waitcnt lgkmcnt(6)
    v_mfma_f32_32x32x16_bf16 v[148:163], a[76:79], v[208:211], v[148:163]
    buffer_load_dwordx4 v15, s[52:55], s33 offen offset:1024 lds
    s_add_u32 s85, s85, 1
    s_and_b32 s85, s85, 7
    v_mfma_f32_16x16x32_bf16 v[176:179], v[212:215], a[76:79], v[176:179]
    ds_read_b128 a[84:87], v32 offset:32768
    s_waitcnt lgkmcnt(5)
    v_mfma_f32_32x32x16_bf16 v[100:115], a[80:83], v[180:183], v[100:115]
    buffer_store_dwordx4 v[24:27], v18, s[56:59], s89 offen offset:0 sc1
    s_lshl_b32 s32, s85, 7
    s_add_u32 s32, s32, s90
    s_add_u32 m0, s31, 98304
    s_mul_i32 s33, s85, s3
    buffer_load_dwordx4 v9, s[40:43], s32 offen offset:0 lds
    ds_read_b128 v[196:199], v42 offset:49152
    s_waitcnt lgkmcnt(5)
    v_mfma_f32_32x32x16_bf16 v[116:131], a[80:83], v[184:187], v[116:131]
    ds_read_b128 v[200:203], v42 offset:53248
    s_waitcnt lgkmcnt(5)
    v_mfma_f32_32x32x16_bf16 v[132:147], a[80:83], v[188:191], v[132:147]
    buffer_load_dwordx4 v10, s[40:43], s32 offen offset:1024 lds
    ds_read_b128 v[204:207], v42 offset:57344
    s_waitcnt lgkmcnt(5)
    v_mfma_f32_32x32x16_bf16 v[148:163], a[80:83], v[192:195], v[148:163]
    ds_read_b128 v[208:211], v42 offset:61440
    s_waitcnt lgkmcnt(5)
    v_mfma_f32_16x16x32_bf16 v[164:167], v[216:219], a[80:83], v[164:167]
    ds_read_b128 a[88:91], v33 offset:32768
    s_waitcnt lgkmcnt(4)
    v_mfma_f32_32x32x16_bf16 v[100:115], a[84:87], v[196:199], v[100:115]
    buffer_store_dwordx4 v[24:27], v18, s[56:59], s89 offen offset:1024 sc1
    buffer_load_dwordx4 v11, s[40:43], s32 offen offset:2048 lds
    ds_read_b128 v[180:183], v43 offset:49152
    s_waitcnt lgkmcnt(4)
    v_mfma_f32_32x32x16_bf16 v[116:131], a[84:87], v[200:203], v[116:131]
    ds_read_b128 v[184:187], v43 offset:53248
    s_waitcnt lgkmcnt(4)
    v_mfma_f32_32x32x16_bf16 v[132:147], a[84:87], v[204:207], v[132:147]
    buffer_load_dwordx4 v12, s[40:43], s32 offen offset:3072 lds
    ds_read_b128 v[188:191], v43 offset:57344
    s_waitcnt lgkmcnt(4)
    v_mfma_f32_32x32x16_bf16 v[148:163], a[84:87], v[208:211], v[148:163]
    ds_read_b128 v[192:195], v43 offset:61440
    v_mfma_f32_16x16x32_bf16 v[168:171], v[216:219], a[84:87], v[168:171]
    ds_read_b128 a[92:95], v34 offset:32768
    s_waitcnt lgkmcnt(4)
    v_mfma_f32_32x32x16_bf16 v[100:115], a[88:91], v[180:183], v[100:115]
    s_add_u32 m0, s34, 114688
    s_add_u32 s33, s33, s91
    buffer_load_dwordx4 v14, s[48:51], s33 offen offset:0 lds
    ds_read_b128 v[196:199], v44 offset:49152
    s_waitcnt lgkmcnt(4)
    v_mfma_f32_32x32x16_bf16 v[116:131], a[88:91], v[184:187], v[116:131]
    ds_read_b128 v[200:203], v44 offset:53248
    s_waitcnt lgkmcnt(4)
    v_mfma_f32_32x32x16_bf16 v[132:147], a[88:91], v[188:191], v[132:147]
    buffer_load_dwordx4 v15, s[48:51], s33 offen offset:1024 lds
    ds_read_b128 v[204:207], v44 offset:57344
    s_waitcnt lgkmcnt(4)
    v_mfma_f32_32x32x16_bf16 v[148:163], a[88:91], v[192:195], v[148:163]
    ds_read_b128 v[208:211], v44 offset:61440
    v_mfma_f32_16x16x32_bf16 v[172:175], v[216:219], a[88:91], v[172:175]
    s_waitcnt lgkmcnt(3)
    v_mfma_f32_32x32x16_bf16 v[100:115], a[92:95], v[196:199], v[100:115]
    s_waitcnt vmcnt(8)
    s_barrier
    ds_read_b128 a[96:99], v45 offset:0
    ds_read_b128 v[180:183], v49 offset:16384
    s_waitcnt lgkmcnt(4)
    v_mfma_f32_32x32x16_bf16 v[116:131], a[92:95], v[200:203], v[116:131]
    ds_read_b128 v[184:187], v49 offset:20480
    ds_read_b128 v[188:191], v49 offset:24576
    s_waitcnt lgkmcnt(5)
    v_mfma_f32_32x32x16_bf16 v[132:147], a[92:95], v[204:207], v[132:147]
    s_add_u32 m0, s34, 122880
    s_add_u32 s33, s33, s30
    buffer_load_dwordx4 v14, s[52:55], s33 offen offset:0 lds
    ds_read_b128 v[192:195], v49 offset:28672
    ds_read_b128 v[212:215], v53 offset:768
    s_waitcnt lgkmcnt(6)
    v_mfma_f32_32x32x16_bf16 v[148:163], a[92:95], v[208:211], v[148:163]
    buffer_load_dwordx4 v15, s[52:55], s33 offen offset:1024 lds
    s_add_u32 s85, s85, 1
    s_and_b32 s85, s85, 7
    v_mfma_f32_16x16x32_bf16 v[176:179], v[216:219], a[92:95], v[176:179]
    ds_read_b128 a[100:103], v46 offset:0
    s_waitcnt lgkmcnt(5)
    v_mfma_f32_32x32x16_bf16 v[100:115], a[96:99], v[180:183], v[100:115]
    s_lshr_b32 s33, s31, 2
    s_add_u32 m0, s33, 0
    s_mul_i32 s32, s85, 196608
    s_add_u32 s85, s85, 1
    buffer_load_dwordx4 v23, s[44:47], s32 offen lds
    s_and_b32 s85, s85, 7
    ds_read_b128 v[196:199], v50 offset:16384
    s_waitcnt lgkmcnt(5)
    v_mfma_f32_32x32x16_bf16 v[116:131], a[96:99], v[184:187], v[116:131]
    ds_read_b128 v[200:203], v50 offset:20480
    s_waitcnt lgkmcnt(5)
    v_mfma_f32_32x32x16_bf16 v[132:147], a[96:99], v[188:191], v[132:147]
    s_lshr_b32 s33, s31, 2
    s_add_u32 m0, s33, 4096
    s_mul_i32 s32, s85, 196608
    s_add_u32 s85, s85, 1
    buffer_load_dwordx4 v23, s[44:47], s32 offen lds
    s_and_b32 s85, s85, 7
    ds_read_b128 v[204:207], v50 offset:24576
    s_waitcnt lgkmcnt(5)
    v_mfma_f32_32x32x16_bf16 v[148:163], a[96:99], v[192:195], v[148:163]
    ds_read_b128 v[208:211], v50 offset:28672
    s_waitcnt lgkmcnt(5)
    v_mfma_f32_16x16x32_bf16 v[164:167], v[212:215], a[96:99], v[164:167]
    ds_read_b128 a[104:107], v47 offset:0
    s_waitcnt lgkmcnt(4)
    v_mfma_f32_32x32x16_bf16 v[100:115], a[100:103], v[196:199], v[100:115]
    s_lshr_b32 s33, s31, 2
    s_add_u32 m0, s33, 8192
    s_mul_i32 s32, s85, 196608
    s_add_u32 s85, s85, 1
    buffer_load_dwordx4 v23, s[44:47], s32 offen lds
    s_and_b32 s85, s85, 7
    ds_read_b128 v[180:183], v51 offset:16384
    s_waitcnt lgkmcnt(4)
    v_mfma_f32_32x32x16_bf16 v[116:131], a[100:103], v[200:203], v[116:131]
    ds_read_b128 v[184:187], v51 offset:20480
    s_waitcnt lgkmcnt(4)
    v_mfma_f32_32x32x16_bf16 v[132:147], a[100:103], v[204:207], v[132:147]
    s_lshr_b32 s33, s31, 2
    s_add_u32 m0, s33, 12288
    s_mul_i32 s32, s85, 196608
    s_add_u32 s85, s85, 1
    buffer_load_dwordx4 v23, s[44:47], s32 offen lds
    s_and_b32 s85, s85, 7
    ds_read_b128 v[188:191], v51 offset:24576
    s_waitcnt lgkmcnt(4)
    v_mfma_f32_32x32x16_bf16 v[148:163], a[100:103], v[208:211], v[148:163]
    ds_read_b128 v[192:195], v51 offset:28672
    v_mfma_f32_16x16x32_bf16 v[168:171], v[212:215], a[100:103], v[168:171]
    ds_read_b128 a[108:111], v48 offset:0
    s_waitcnt lgkmcnt(4)
    v_mfma_f32_32x32x16_bf16 v[100:115], a[104:107], v[180:183], v[100:115]
    s_lshr_b32 s33, s31, 2
    s_add_u32 m0, s33, 16384
    s_mul_i32 s32, s85, 196608
    s_add_u32 s85, s85, 1
    buffer_load_dwordx4 v23, s[44:47], s32 offen lds
    s_and_b32 s85, s85, 7
    ds_read_b128 v[196:199], v52 offset:16384
    s_waitcnt lgkmcnt(4)
    v_mfma_f32_32x32x16_bf16 v[116:131], a[104:107], v[184:187], v[116:131]
    ds_read_b128 v[200:203], v52 offset:20480
    s_waitcnt lgkmcnt(4)
    v_mfma_f32_32x32x16_bf16 v[132:147], a[104:107], v[188:191], v[132:147]
    s_lshr_b32 s33, s31, 2
    s_add_u32 m0, s33, 20480
    s_mul_i32 s32, s85, 196608
    s_add_u32 s85, s85, 1
    buffer_load_dwordx4 v23, s[44:47], s32 offen lds
    s_and_b32 s85, s85, 7
    ds_read_b128 v[204:207], v52 offset:24576
    s_waitcnt lgkmcnt(4)
    v_mfma_f32_32x32x16_bf16 v[148:163], a[104:107], v[192:195], v[148:163]
    ds_read_b128 v[208:211], v52 offset:28672
    v_mfma_f32_16x16x32_bf16 v[172:175], v[212:215], a[104:107], v[172:175]
    s_waitcnt lgkmcnt(3)
    v_mfma_f32_32x32x16_bf16 v[100:115], a[108:111], v[196:199], v[100:115]
    s_waitcnt vmcnt(6)
    s_barrier
    buffer_store_dword v17, v61, s[56:59], s26 offen offset:1024 sc1
    ds_read_b128 a[112:115], v45 offset:32768
    ds_read_b128 v[180:183], v49 offset:49152
    s_waitcnt lgkmcnt(4)
    v_mfma_f32_32x32x16_bf16 v[116:131], a[108:111], v[200:203], v[116:131]
    ds_read_b128 v[184:187], v49 offset:53248
    ds_read_b128 v[188:191], v49 offset:57344
    s_waitcnt lgkmcnt(5)
    v_mfma_f32_32x32x16_bf16 v[132:147], a[108:111], v[204:207], v[132:147]
    s_lshr_b32 s33, s31, 2
    s_add_u32 m0, s33, 24576
    s_mul_i32 s32, s85, 196608
    s_add_u32 s85, s85, 1
    buffer_load_dwordx4 v23, s[44:47], s32 offen lds
    s_and_b32 s85, s85, 7
    ds_read_b128 v[192:195], v49 offset:61440
    ds_read_b128 v[216:219], v53 offset:896
    s_waitcnt lgkmcnt(6)
    v_mfma_f32_32x32x16_bf16 v[148:163], a[108:111], v[208:211], v[148:163]
    s_lshr_b32 s33, s31, 2
    s_add_u32 m0, s33, 28672
    s_mul_i32 s32, s85, 196608
    s_add_u32 s85, s85, 1
    buffer_load_dwordx4 v23, s[44:47], s32 offen lds
    s_and_b32 s85, s85, 7
    v_mfma_f32_16x16x32_bf16 v[176:179], v[212:215], a[108:111], v[176:179]
    ds_read_b128 a[116:119], v46 offset:32768
    s_waitcnt lgkmcnt(5)
    v_mfma_f32_32x32x16_bf16 v[100:115], a[112:115], v[180:183], v[100:115]
    s_mul_i32 s33, s80, 8192
    s_add_u32 m0, s33, 32768
    s_xor_b32 s32, s35, 0
    s_lshl_b32 s32, s32, 7
    s_add_u32 s32, s32, s36
    buffer_load_dwordx4 v3, s[64:67], s32 offen offset:0 lds
    ds_read_b128 v[196:199], v50 offset:49152
    s_waitcnt lgkmcnt(5)
    v_mfma_f32_32x32x16_bf16 v[116:131], a[112:115], v[184:187], v[116:131]
    ds_read_b128 v[200:203], v50 offset:53248
    s_waitcnt lgkmcnt(5)
    v_mfma_f32_32x32x16_bf16 v[132:147], a[112:115], v[188:191], v[132:147]
    s_add_u32 s32, s32, 7168
    buffer_load_dwordx4 v13, s[64:67], s32 offen offset:1024 lds
    ds_read_b128 v[204:207], v50 offset:57344
    s_waitcnt lgkmcnt(5)
    v_mfma_f32_32x32x16_bf16 v[148:163], a[112:115], v[192:195], v[148:163]
    ds_read_b128 v[208:211], v50 offset:61440
    s_waitcnt lgkmcnt(5)
    v_mfma_f32_16x16x32_bf16 v[164:167], v[216:219], a[112:115], v[164:167]
    ds_read_b128 a[120:123], v47 offset:32768
    s_waitcnt lgkmcnt(4)
    v_mfma_f32_32x32x16_bf16 v[100:115], a[116:119], v[196:199], v[100:115]
    s_add_u32 s32, s32, 7168
    buffer_load_dwordx4 v3, s[64:67], s32 offen offset:2048 lds
    ds_read_b128 v[180:183], v51 offset:49152
    s_waitcnt lgkmcnt(4)
    v_mfma_f32_32x32x16_bf16 v[116:131], a[116:119], v[200:203], v[116:131]
    ds_read_b128 v[184:187], v51 offset:53248
    s_waitcnt lgkmcnt(4)
    v_mfma_f32_32x32x16_bf16 v[132:147], a[116:119], v[204:207], v[132:147]
    s_add_u32 s32, s32, 7168
    buffer_load_dwordx4 v13, s[64:67], s32 offen offset:3072 lds
    ds_read_b128 v[188:191], v51 offset:57344
    s_waitcnt lgkmcnt(4)
    v_mfma_f32_32x32x16_bf16 v[148:163], a[116:119], v[208:211], v[148:163]
    ds_read_b128 v[192:195], v51 offset:61440
    v_mfma_f32_16x16x32_bf16 v[168:171], v[216:219], a[116:119], v[168:171]
    ds_read_b128 a[124:127], v48 offset:32768
    s_waitcnt lgkmcnt(4)
    v_mfma_f32_32x32x16_bf16 v[100:115], a[120:123], v[180:183], v[100:115]
    s_add_u32 m0, s33, 36864
    s_add_u32 s32, s32, 11264
    buffer_load_dwordx4 v3, s[64:67], s32 offen offset:0 lds
    ds_read_b128 v[196:199], v52 offset:49152
    s_waitcnt lgkmcnt(4)
    v_mfma_f32_32x32x16_bf16 v[116:131], a[120:123], v[184:187], v[116:131]
    ds_read_b128 v[200:203], v52 offset:53248
    s_waitcnt lgkmcnt(4)
    v_mfma_f32_32x32x16_bf16 v[132:147], a[120:123], v[188:191], v[132:147]
    s_add_u32 s32, s32, 7168
    buffer_load_dwordx4 v13, s[64:67], s32 offen offset:1024 lds
    ds_read_b128 v[204:207], v52 offset:57344
    s_waitcnt lgkmcnt(4)
    v_mfma_f32_32x32x16_bf16 v[148:163], a[120:123], v[192:195], v[148:163]
    ds_read_b128 v[208:211], v52 offset:61440
    v_mfma_f32_16x16x32_bf16 v[172:175], v[216:219], a[120:123], v[172:175]
    s_waitcnt lgkmcnt(3)
    v_mfma_f32_32x32x16_bf16 v[100:115], a[124:127], v[196:199], v[100:115]
    s_add_u32 s32, s32, 7168
    buffer_load_dwordx4 v3, s[64:67], s32 offen offset:2048 lds
    s_waitcnt lgkmcnt(2)
    v_mfma_f32_32x32x16_bf16 v[116:131], a[124:127], v[200:203], v[116:131]
    s_waitcnt lgkmcnt(1)
    v_mfma_f32_32x32x16_bf16 v[132:147], a[124:127], v[204:207], v[132:147]
    s_add_u32 s32, s32, 7168
    buffer_load_dwordx4 v13, s[64:67], s32 offen offset:3072 lds
    s_waitcnt lgkmcnt(0)
    v_mfma_f32_32x32x16_bf16 v[148:163], a[124:127], v[208:211], v[148:163]
    v_mfma_f32_16x16x32_bf16 v[176:179], v[216:219], a[124:127], v[176:179]
    s_nop 0
    v_pk_fma_f32 v[22:23], v[66:67], v[100:101], v[102:103] op_sel_hi:[0,1,1]
    s_nop 2
    v_pk_fma_f32 v[42:43], v[66:67], v[116:117], v[118:119] op_sel:[1,0,0]
    s_nop 0
    v_pk_fma_f32 v[24:25], v[66:67], v[132:133], v[134:135] op_sel_hi:[0,1,1]
    s_nop 2
    v_pk_fma_f32 v[44:45], v[66:67], v[148:149], v[150:151] op_sel:[1,0,0]
    v_pk_fma_f32 v[22:23], v[72:73], v[132:133], v[22:23] op_sel_hi:[0,1,1] neg_lo:[1,0,0] neg_hi:[1,0,0]
    v_pk_fma_f32 v[42:43], v[72:73], v[148:149], v[42:43] op_sel:[1,0,0] neg_lo:[1,0,0] neg_hi:[1,0,0]
    v_pk_fma_f32 v[24:25], v[72:73], v[100:101], v[24:25] op_sel_hi:[0,1,1]
    v_pk_fma_f32 v[44:45], v[72:73], v[116:117], v[44:45] op_sel:[1,0,0]
    v_pk_fma_f32 v[10:11], v[66:67], v[22:23], v[104:105] op_sel_hi:[0,1,1]
    v_pk_fma_f32 v[26:27], v[66:67], v[42:43], v[120:121] op_sel:[1,0,0]
    v_pk_fma_f32 v[14:15], v[66:67], v[24:25], v[136:137] op_sel_hi:[0,1,1]
    v_pk_fma_f32 v[32:33], v[66:67], v[44:45], v[152:153] op_sel:[1,0,0]
    v_pk_fma_f32 v[10:11], v[72:73], v[24:25], v[10:11] op_sel_hi:[0,1,1] neg_lo:[1,0,0] neg_hi:[1,0,0]
    v_pk_fma_f32 v[26:27], v[72:73], v[44:45], v[26:27] op_sel:[1,0,0] neg_lo:[1,0,0] neg_hi:[1,0,0]
    v_pk_fma_f32 v[14:15], v[72:73], v[22:23], v[14:15] op_sel_hi:[0,1,1]
    v_pk_fma_f32 v[32:33], v[72:73], v[42:43], v[32:33] op_sel:[1,0,0]
    v_pk_fma_f32 v[22:23], v[66:67], v[10:11], v[106:107] op_sel_hi:[0,1,1]
    v_pk_fma_f32 v[42:43], v[66:67], v[26:27], v[122:123] op_sel:[1,0,0]
    v_pk_fma_f32 v[24:25], v[66:67], v[14:15], v[138:139] op_sel_hi:[0,1,1]
    v_pk_fma_f32 v[44:45], v[66:67], v[32:33], v[154:155] op_sel:[1,0,0]
    v_pk_fma_f32 v[22:23], v[72:73], v[14:15], v[22:23] op_sel_hi:[0,1,1] neg_lo:[1,0,0] neg_hi:[1,0,0]
    v_pk_fma_f32 v[42:43], v[72:73], v[32:33], v[42:43] op_sel:[1,0,0] neg_lo:[1,0,0] neg_hi:[1,0,0]
    v_pk_fma_f32 v[24:25], v[72:73], v[10:11], v[24:25] op_sel_hi:[0,1,1]
    v_pk_fma_f32 v[44:45], v[72:73], v[26:27], v[44:45] op_sel:[1,0,0]
    v_pk_fma_f32 v[10:11], v[66:67], v[22:23], v[108:109] op_sel_hi:[0,1,1]
    v_pk_fma_f32 v[26:27], v[66:67], v[42:43], v[124:125] op_sel:[1,0,0]
    v_pk_fma_f32 v[14:15], v[66:67], v[24:25], v[140:141] op_sel_hi:[0,1,1]
    v_pk_fma_f32 v[32:33], v[66:67], v[44:45], v[156:157] op_sel:[1,0,0]
    v_pk_fma_f32 v[10:11], v[72:73], v[24:25], v[10:11] op_sel_hi:[0,1,1] neg_lo:[1,0,0] neg_hi:[1,0,0]
    v_pk_fma_f32 v[26:27], v[72:73], v[44:45], v[26:27] op_sel:[1,0,0] neg_lo:[1,0,0] neg_hi:[1,0,0]
    v_pk_fma_f32 v[14:15], v[72:73], v[22:23], v[14:15] op_sel_hi:[0,1,1]
    v_pk_fma_f32 v[32:33], v[72:73], v[42:43], v[32:33] op_sel:[1,0,0]
    v_pk_fma_f32 v[22:23], v[66:67], v[10:11], v[110:111] op_sel_hi:[0,1,1]
    v_pk_fma_f32 v[42:43], v[66:67], v[26:27], v[126:127] op_sel:[1,0,0]
    v_pk_fma_f32 v[24:25], v[66:67], v[14:15], v[142:143] op_sel_hi:[0,1,1]
    v_pk_fma_f32 v[44:45], v[66:67], v[32:33], v[158:159] op_sel:[1,0,0]
    v_pk_fma_f32 v[22:23], v[72:73], v[14:15], v[22:23] op_sel_hi:[0,1,1] neg_lo:[1,0,0] neg_hi:[1,0,0]
    v_pk_fma_f32 v[42:43], v[72:73], v[32:33], v[42:43] op_sel:[1,0,0] neg_lo:[1,0,0] neg_hi:[1,0,0]
    v_pk_fma_f32 v[24:25], v[72:73], v[10:11], v[24:25] op_sel_hi:[0,1,1]
    v_pk_fma_f32 v[44:45], v[72:73], v[26:27], v[44:45] op_sel:[1,0,0]
    v_pk_fma_f32 v[10:11], v[66:67], v[22:23], v[112:113] op_sel_hi:[0,1,1]
    v_pk_fma_f32 v[26:27], v[66:67], v[42:43], v[128:129] op_sel:[1,0,0]
    v_pk_fma_f32 v[14:15], v[66:67], v[24:25], v[144:145] op_sel_hi:[0,1,1]
    v_pk_fma_f32 v[32:33], v[66:67], v[44:45], v[160:161] op_sel:[1,0,0]
    v_pk_fma_f32 v[10:11], v[72:73], v[24:25], v[10:11] op_sel_hi:[0,1,1] neg_lo:[1,0,0] neg_hi:[1,0,0]
    v_pk_fma_f32 v[26:27], v[72:73], v[44:45], v[26:27] op_sel:[1,0,0] neg_lo:[1,0,0] neg_hi:[1,0,0]
    v_pk_fma_f32 v[14:15], v[72:73], v[22:23], v[14:15] op_sel_hi:[0,1,1]
    v_pk_fma_f32 v[32:33], v[72:73], v[42:43], v[32:33] op_sel:[1,0,0]
    v_pk_fma_f32 v[22:23], v[66:67], v[10:11], v[114:115] op_sel_hi:[0,1,1]
    v_pk_fma_f32 v[42:43], v[66:67], v[26:27], v[130:131] op_sel:[1,0,0]
    v_pk_fma_f32 v[24:25], v[66:67], v[14:15], v[146:147] op_sel_hi:[0,1,1]
    v_pk_fma_f32 v[44:45], v[66:67], v[32:33], v[162:163] op_sel:[1,0,0]
    v_pk_fma_f32 v[22:23], v[72:73], v[14:15], v[22:23] op_sel_hi:[0,1,1] neg_lo:[1,0,0] neg_hi:[1,0,0]
    v_pk_fma_f32 v[42:43], v[72:73], v[32:33], v[42:43] op_sel:[1,0,0] neg_lo:[1,0,0] neg_hi:[1,0,0]
    v_pk_fma_f32 v[24:25], v[72:73], v[10:11], v[24:25] op_sel_hi:[0,1,1]
    v_pk_fma_f32 v[44:45], v[72:73], v[26:27], v[44:45] op_sel:[1,0,0]
    v_fma_f32 v48, v74, v22, v23
    v_fma_f32 v50, v74, v24, v25
    v_fma_f32 v49, v75, v42, v43
    v_fma_f32 v51, v75, v44, v45
    v_fma_f32 v48, -v76, v24, v48
    v_fma_f32 v50, v76, v22, v50
    v_fma_f32 v49, -v77, v44, v49
    v_fma_f32 v51, v77, v42, v51
    ds_write_b128 v4, v[48:51] offset:3584
    s_waitcnt vmcnt(8) lgkmcnt(0)
    s_barrier
    ds_read_b128 v[180:183], v4 offset:0
    ds_read_b128 v[184:187], v4 offset:512
    ds_read_b128 v[188:191], v4 offset:1024
    ds_read_b128 v[192:195], v4 offset:1536
    ds_read_b128 v[196:199], v4 offset:2048
    ds_read_b128 v[200:203], v4 offset:2560
    ds_read_b128 v[204:207], v4 offset:3072
    v_add_f32 v164, v164, v169
    v_add_f32 v174, v174, v179
    v_add_f32 v164, v164, v174
    v_cvt_pk_bf16_f32 v164, v164, v164
    v_and_b32 v164, 0xffff0000, v164
    v_mul_f32 v164, 3216550459, v164
    v_exp_f32 v164, v164
    s_nop 0
    v_add_f32 v164, 1.0, v164
    s_waitcnt lgkmcnt(5)
    v_pk_fma_f32 v[184:185], v[78:79], v[180:181], v[184:185]
    v_pk_fma_f32 v[186:187], v[78:79], v[182:183], v[186:187]
    v_pk_fma_f32 v[184:185], v[80:81], v[182:183], v[184:185] neg_lo:[1,0,0] neg_hi:[1,0,0]
    v_pk_fma_f32 v[186:187], v[80:81], v[180:181], v[186:187]
    s_waitcnt lgkmcnt(4)
    v_pk_fma_f32 v[188:189], v[78:79], v[184:185], v[188:189]
    v_pk_fma_f32 v[190:191], v[78:79], v[186:187], v[190:191]
    v_pk_fma_f32 v[188:189], v[80:81], v[186:187], v[188:189] neg_lo:[1,0,0] neg_hi:[1,0,0]
    v_pk_fma_f32 v[190:191], v[80:81], v[184:185], v[190:191]
    s_waitcnt lgkmcnt(3)
    v_pk_fma_f32 v[192:193], v[78:79], v[188:189], v[192:193]
    v_pk_fma_f32 v[194:195], v[78:79], v[190:191], v[194:195]
    v_pk_fma_f32 v[192:193], v[80:81], v[190:191], v[192:193] neg_lo:[1,0,0] neg_hi:[1,0,0]
    v_pk_fma_f32 v[194:195], v[80:81], v[188:189], v[194:195]
    s_waitcnt lgkmcnt(2)
    v_pk_fma_f32 v[196:197], v[78:79], v[192:193], v[196:197]
    v_pk_fma_f32 v[198:199], v[78:79], v[194:195], v[198:199]
    v_pk_fma_f32 v[196:197], v[80:81], v[194:195], v[196:197] neg_lo:[1,0,0] neg_hi:[1,0,0]
    v_pk_fma_f32 v[198:199], v[80:81], v[192:193], v[198:199]
    s_waitcnt lgkmcnt(1)
    v_pk_fma_f32 v[200:201], v[78:79], v[196:197], v[200:201]
    v_pk_fma_f32 v[202:203], v[78:79], v[198:199], v[202:203]
    v_pk_fma_f32 v[200:201], v[80:81], v[198:199], v[200:201] neg_lo:[1,0,0] neg_hi:[1,0,0]
    v_pk_fma_f32 v[202:203], v[80:81], v[196:197], v[202:203]
    s_waitcnt lgkmcnt(0)
    v_pk_fma_f32 v[204:205], v[78:79], v[200:201], v[204:205]
    v_pk_fma_f32 v[206:207], v[78:79], v[202:203], v[206:207]
    v_pk_fma_f32 v[204:205], v[80:81], v[202:203], v[204:205] neg_lo:[1,0,0] neg_hi:[1,0,0]
    v_pk_fma_f32 v[206:207], v[80:81], v[200:201], v[206:207]
    v_pk_fma_f32 v[48:49], v[78:79], v[204:205], v[48:49]
    v_pk_fma_f32 v[50:51], v[78:79], v[206:207], v[50:51]
    v_pk_fma_f32 v[48:49], v[80:81], v[206:207], v[48:49] neg_lo:[1,0,0] neg_hi:[1,0,0]
    v_pk_fma_f32 v[50:51], v[80:81], v[204:205], v[50:51]
    buffer_store_dwordx4 v[48:51], v29, s[56:59], s25 offen sc1
    s_mov_b32 s39, 4096
    buffer_load_dwordx4 v[208:211], v18, s[56:59], s39 offen sc1
    ds_read_b64_tr_b16 v[212:213], v54 offset:0
    ds_read_b64_tr_b16 v[214:215], v54 offset:256
    ds_read_b64_tr_b16 v[216:217], v54 offset:1024
    ds_read_b64_tr_b16 v[218:219], v54 offset:1280
    ds_read_b64_tr_b16 v[244:245], v54 offset:2048
    ds_read_b64_tr_b16 v[246:247], v54 offset:2304
    v_rcp_f32 v164, v164
    s_nop 0
    v_cvt_pk_bf16_f32 v164, v164, v164
    v_and_b32 v12, 0xffff0000, v164
    v_sub_f32 v164, 1.0, v12
    v_cvt_pk_bf16_f32 v164, v164, v164
    v_and_b32 v28, 0xffff0000, v164
    v_pk_mul_f32 v[164:165], v[204:205], v[94:95]
    v_pk_mul_f32 v[166:167], v[206:207], v[94:95]
    v_pk_fma_f32 v[164:165], v[206:207], v[96:97], v[164:165] neg_lo:[1,0,0] neg_hi:[1,0,0]
    v_pk_fma_f32 v[166:167], v[204:205], v[96:97], v[166:167]
    s_waitcnt lgkmcnt(4)
    v_mfma_f32_32x32x16_bf16 v[228:243], v[212:215], a[0:3], 0
    ds_read_b64_tr_b16 v[248:249], v54 offset:3072
    ds_read_b64_tr_b16 v[250:251], v54 offset:3328
    s_mul_i32 s33, s80, 16384
    s_add_u32 m0, s33, 65536
    s_xor_b32 s32, s35, 0
    s_lshl_b32 s32, s32, 7
    s_add_u32 s32, s32, s36
    buffer_load_dwordx4 v3, s[68:71], s32 offen offset:0 lds
    s_waitcnt lgkmcnt(4)
    v_mfma_f32_32x32x16_bf16 v[228:243], v[216:219], a[4:7], v[228:243]
    ds_read_b64_tr_b16 v[212:213], v54 offset:4096
    ds_read_b64_tr_b16 v[214:215], v54 offset:4352
    v_mul_f32 v168, v22, v94
    v_mul_f32 v170, v24, v94
    v_fma_f32 v168, -v24, v96, v168
    s_waitcnt lgkmcnt(4)
    v_mfma_f32_32x32x16_bf16 v[228:243], v[244:247], a[8:11], v[228:243]
    ds_read_b64_tr_b16 v[216:217], v54 offset:5120
    ds_read_b64_tr_b16 v[218:219], v54 offset:5376
    s_add_u32 s32, s32, 7168
    buffer_load_dwordx4 v13, s[68:71], s32 offen offset:1024 lds
    v_fma_f32 v170, v22, v96, v170
    v_mul_f32 v169, v42, v95
    s_waitcnt lgkmcnt(4)
    v_mfma_f32_32x32x16_bf16 v[228:243], v[248:251], a[12:15], v[228:243]
    ds_read_b64_tr_b16 v[244:245], v54 offset:6144
    ds_read_b64_tr_b16 v[246:247], v54 offset:6400
    v_mul_f32 v171, v44, v95
    v_fma_f32 v169, -v44, v97, v169
    v_fma_f32 v171, v42, v97, v171
    s_waitcnt lgkmcnt(4)
    v_mfma_f32_32x32x16_bf16 v[228:243], v[212:215], a[16:19], v[228:243]
    ds_read_b64_tr_b16 v[248:249], v54 offset:7168
    ds_read_b64_tr_b16 v[250:251], v54 offset:7424
    s_add_u32 s32, s32, 7168
    buffer_load_dwordx4 v3, s[68:71], s32 offen offset:2048 lds
    v_mul_f32 v46, v96, v100
    v_mul_f32 v100, v94, v100
    s_waitcnt lgkmcnt(4)
    v_mfma_f32_32x32x16_bf16 v[228:243], v[216:219], a[20:23], v[228:243]
    ds_read_b64_tr_b16 v[212:213], v54 offset:8192
    ds_read_b64_tr_b16 v[214:215], v54 offset:8448
    v_mul_f32 v47, v96, v101
    v_mul_f32 v101, v94, v101
    v_fma_f32 v100, -v96, v132, v100
    s_waitcnt lgkmcnt(4)
    v_mfma_f32_32x32x16_bf16 v[228:243], v[244:247], a[24:27], v[228:243]
    ds_read_b64_tr_b16 v[216:217], v54 offset:9216
    ds_read_b64_tr_b16 v[218:219], v54 offset:9472
    s_add_u32 s32, s32, 7168
    buffer_load_dwordx4 v13, s[68:71], s32 offen offset:3072 lds
    v_fma_f32 v132, v94, v132, v46
    v_fma_f32 v101, -v96, v133, v101
    s_waitcnt lgkmcnt(4)
    v_mfma_f32_32x32x16_bf16 v[228:243], v[248:251], a[28:31], v[228:243]
    ds_read_b64_tr_b16 v[244:245], v54 offset:10240
    ds_read_b64_tr_b16 v[246:247], v54 offset:10496
    v_fma_f32 v133, v94, v133, v47
    v_mul_f32 v46, v96, v102
    v_mul_f32 v102, v94, v102
    s_waitcnt lgkmcnt(4)
    v_mfma_f32_32x32x16_bf16 v[228:243], v[212:215], a[32:35], v[228:243]
    ds_read_b64_tr_b16 v[248:249], v54 offset:11264
    ds_read_b64_tr_b16 v[250:251], v54 offset:11520
    s_add_u32 m0, s33, 69632
    s_add_u32 s32, s32, 11264
    buffer_load_dwordx4 v3, s[68:71], s32 offen offset:0 lds
    v_mul_f32 v47, v96, v103
    s_waitcnt lgkmcnt(4)
    v_mfma_f32_32x32x16_bf16 v[228:243], v[216:219], a[36:39], v[228:243]
    ds_read_b64_tr_b16 v[212:213], v54 offset:12288
    ds_read_b64_tr_b16 v[214:215], v54 offset:12544
    v_mul_f32 v103, v94, v103
    v_fma_f32 v102, -v96, v134, v102
    v_fma_f32 v134, v94, v134, v46
    s_waitcnt lgkmcnt(4)
    v_mfma_f32_32x32x16_bf16 v[228:243], v[244:247], a[40:43], v[228:243]
    ds_read_b64_tr_b16 v[216:217], v54 offset:13312
    ds_read_b64_tr_b16 v[218:219], v54 offset:13568
    s_add_u32 s32, s32, 7168
    buffer_load_dwordx4 v13, s[68:71], s32 offen offset:1024 lds
    v_fma_f32 v103, -v96, v135, v103
    v_fma_f32 v135, v94, v135, v47
    s_waitcnt lgkmcnt(4)
    v_mfma_f32_32x32x16_bf16 v[228:243], v[248:251], a[44:47], v[228:243]
    ds_read_b64_tr_b16 v[244:245], v54 offset:14336
    ds_read_b64_tr_b16 v[246:247], v54 offset:14592
    v_mul_f32 v46, v96, v104
    v_mul_f32 v104, v94, v104
    v_mul_f32 v47, v96, v105
    s_waitcnt lgkmcnt(4)
    v_mfma_f32_32x32x16_bf16 v[228:243], v[212:215], a[48:51], v[228:243]
    ds_read_b64_tr_b16 v[248:249], v54 offset:15360
    ds_read_b64_tr_b16 v[250:251], v54 offset:15616
    s_add_u32 s32, s32, 7168
    buffer_load_dwordx4 v3, s[68:71], s32 offen offset:2048 lds
    v_mul_f32 v105, v94, v105
    v_fma_f32 v104, -v96, v136, v104
    s_waitcnt lgkmcnt(4)
    v_mfma_f32_32x32x16_bf16 v[228:243], v[216:219], a[52:55], v[228:243]
    ds_read_b64_tr_b16 v[212:213], v54 offset:16384
    ds_read_b64_tr_b16 v[214:215], v54 offset:16640
    v_fma_f32 v136, v94, v136, v46
    v_fma_f32 v105, -v96, v137, v105
    v_fma_f32 v137, v94, v137, v47
    s_waitcnt lgkmcnt(4)
    v_mfma_f32_32x32x16_bf16 v[228:243], v[244:247], a[56:59], v[228:243]
    ds_read_b64_tr_b16 v[216:217], v54 offset:17408
    ds_read_b64_tr_b16 v[218:219], v54 offset:17664
    s_add_u32 s32, s32, 7168
    buffer_load_dwordx4 v13, s[68:71], s32 offen offset:3072 lds
    v_mul_f32 v46, v96, v106
    v_mul_f32 v106, v94, v106
    s_waitcnt lgkmcnt(4)
    v_mfma_f32_32x32x16_bf16 v[228:243], v[248:251], a[60:63], v[228:243]
    ds_read_b64_tr_b16 v[244:245], v54 offset:18432
    ds_read_b64_tr_b16 v[246:247], v54 offset:18688
    v_mul_f32 v47, v96, v107
    v_mul_f32 v107, v94, v107
    v_fma_f32 v106, -v96, v138, v106
    s_waitcnt lgkmcnt(4)
    v_mfma_f32_32x32x16_bf16 v[228:243], v[212:215], a[64:67], v[228:243]
    ds_read_b64_tr_b16 v[248:249], v54 offset:19456
    ds_read_b64_tr_b16 v[250:251], v54 offset:19712
    v_fma_f32 v138, v94, v138, v46
    v_fma_f32 v107, -v96, v139, v107
    v_fma_f32 v139, v94, v139, v47
    s_waitcnt lgkmcnt(4)
    v_mfma_f32_32x32x16_bf16 v[228:243], v[216:219], a[68:71], v[228:243]
    ds_read_b64_tr_b16 v[212:213], v54 offset:20480
    ds_read_b64_tr_b16 v[214:215], v54 offset:20736
    v_mul_f32 v46, v96, v108
    v_mul_f32 v108, v94, v108
    v_mul_f32 v47, v96, v109
    s_waitcnt lgkmcnt(4)
    v_mfma_f32_32x32x16_bf16 v[228:243], v[244:247], a[72:75], v[228:243]
    ds_read_b64_tr_b16 v[216:217], v54 offset:21504
    ds_read_b64_tr_b16 v[218:219], v54 offset:21760
    v_mul_f32 v109, v94, v109
    v_fma_f32 v108, -v96, v140, v108
    v_fma_f32 v140, v94, v140, v46
    s_waitcnt lgkmcnt(4)
    v_mfma_f32_32x32x16_bf16 v[228:243], v[248:251], a[76:79], v[228:243]
    ds_read_b64_tr_b16 v[244:245], v54 offset:22528
    ds_read_b64_tr_b16 v[246:247], v54 offset:22784
    v_fma_f32 v109, -v96, v141, v109
    v_fma_f32 v141, v94, v141, v47
    v_mul_f32 v46, v96, v110
    s_waitcnt lgkmcnt(4)
    v_mfma_f32_32x32x16_bf16 v[228:243], v[212:215], a[80:83], v[228:243]
    ds_read_b64_tr_b16 v[248:249], v54 offset:23552
    ds_read_b64_tr_b16 v[250:251], v54 offset:23808
    v_mul_f32 v110, v94, v110
    v_mul_f32 v47, v96, v111
    v_mul_f32 v111, v94, v111
    s_waitcnt lgkmcnt(4)
    v_mfma_f32_32x32x16_bf16 v[228:243], v[216:219], a[84:87], v[228:243]
    ds_read_b64_tr_b16 v[212:213], v54 offset:24576
    ds_read_b64_tr_b16 v[214:215], v54 offset:24832
    v_fma_f32 v110, -v96, v142, v110
    v_fma_f32 v142, v94, v142, v46
    v_fma_f32 v111, -v96, v143, v111
    s_waitcnt lgkmcnt(4)
    v_mfma_f32_32x32x16_bf16 v[228:243], v[244:247], a[88:91], v[228:243]
    ds_read_b64_tr_b16 v[216:217], v54 offset:25600
    ds_read_b64_tr_b16 v[218:219], v54 offset:25856
    s_lshl_b32 s25, s82, 13
    s_add_u32 s25, s25, 655360
gm_ck49:
    s_waitcnt vmcnt(8)
    v_cmp_ne_u64 vcc, s[0:1], v[208:209]
    v_cmp_ne_u64 s[98:99], s[0:1], v[210:211]
    s_nop 3
    s_or_b64 vcc, vcc, s[98:99]
    s_cbranch_scc1 gm_rt51
gm_ok50:
    buffer_load_dwordx4 v[180:183], v20, s[56:59], s25 offen sc1
    buffer_load_dwordx4 v[184:187], v21, s[56:59], s25 offen sc1
    s_waitcnt lgkmcnt(4)
    v_mfma_f32_32x32x16_bf16 v[228:243], v[248:251], a[92:95], v[228:243]
    ds_read_b64_tr_b16 v[244:245], v54 offset:26624
    ds_read_b64_tr_b16 v[246:247], v54 offset:26880
    s_mul_i32 s33, s80, 16384
    s_add_u32 m0, s33, 73728
    s_xor_b32 s32, s35, 1
    s_lshl_b32 s32, s32, 7
    s_add_u32 s32, s32, s36
    buffer_load_dwordx4 v3, s[64:67], s32 offen offset:0 lds
    s_waitcnt lgkmcnt(4)
    v_mfma_f32_32x32x16_bf16 v[228:243], v[212:215], a[96:99], v[228:243]
    ds_read_b64_tr_b16 v[248:249], v54 offset:27648
    ds_read_b64_tr_b16 v[250:251], v54 offset:27904
    s_add_u32 s32, s32, 7168
    buffer_load_dwordx4 v13, s[64:67], s32 offen offset:1024 lds
    v_fma_f32 v143, v94, v143, v47
    v_mul_f32 v46, v96, v112
    s_waitcnt lgkmcnt(4)
    v_mfma_f32_32x32x16_bf16 v[228:243], v[216:219], a[100:103], v[228:243]
    ds_read_b64_tr_b16 v[212:213], v54 offset:28672
    ds_read_b64_tr_b16 v[214:215], v54 offset:28928
    s_add_u32 s32, s32, 7168
    buffer_load_dwordx4 v3, s[64:67], s32 offen offset:2048 lds
    v_mul_f32 v112, v94, v112
    v_mul_f32 v47, v96, v113
    s_waitcnt lgkmcnt(4)
    v_mfma_f32_32x32x16_bf16 v[228:243], v[244:247], a[104:107], v[228:243]
    ds_read_b64_tr_b16 v[216:217], v54 offset:29696
    ds_read_b64_tr_b16 v[218:219], v54 offset:29952
    s_add_u32 s32, s32, 7168
    buffer_load_dwordx4 v13, s[64:67], s32 offen offset:3072 lds
    v_mul_f32 v113, v94, v113
    v_fma_f32 v112, -v96, v144, v112
    s_waitcnt lgkmcnt(4)
    v_mfma_f32_32x32x16_bf16 v[228:243], v[248:251], a[108:111], v[228:243]
    ds_read_b64_tr_b16 v[244:245], v54 offset:30720
    ds_read_b64_tr_b16 v[246:247], v54 offset:30976
    s_add_u32 m0, s33, 77824
    s_add_u32 s32, s32, 11264
    buffer_load_dwordx4 v3, s[64:67], s32 offen offset:0 lds
    v_fma_f32 v144, v94, v144, v46
    s_waitcnt lgkmcnt(4)
    v_mfma_f32_32x32x16_bf16 v[228:243], v[212:215], a[112:115], v[228:243]
    ds_read_b64_tr_b16 v[248:249], v54 offset:31744
    ds_read_b64_tr_b16 v[250:251], v54 offset:32000
    s_add_u32 s32, s32, 7168
    buffer_load_dwordx4 v13, s[64:67], s32 offen offset:1024 lds
    v_fma_f32 v113, -v96, v145, v113
    v_fma_f32 v145, v94, v145, v47
    s_waitcnt lgkmcnt(4)
    v_mfma_f32_32x32x16_bf16 v[228:243], v[216:219], a[116:119], v[228:243]
    s_add_u32 s32, s32, 7168
    buffer_load_dwordx4 v3, s[64:67], s32 offen offset:2048 lds
    v_mul_f32 v46, v96, v114
    v_mul_f32 v114, v94, v114
    v_mul_f32 v47, v96, v115
    v_mul_f32 v115, v94, v115
    s_waitcnt lgkmcnt(2)
    v_mfma_f32_32x32x16_bf16 v[228:243], v[244:247], a[120:123], v[228:243]
    s_add_u32 s32, s32, 7168
    buffer_load_dwordx4 v13, s[64:67], s32 offen offset:3072 lds
    v_fma_f32 v114, -v96, v146, v114
    v_fma_f32 v146, v94, v146, v46
    v_fma_f32 v115, -v96, v147, v115
    v_fma_f32 v147, v94, v147, v47
    s_waitcnt lgkmcnt(0)
    v_mfma_f32_32x32x16_bf16 v[228:243], v[248:251], a[124:127], v[228:243]
    v_mul_f32 v46, v97, v116
    v_mul_f32 v116, v95, v116
    v_mul_f32 v47, v97, v117
    v_mul_f32 v117, v95, v117
    v_fma_f32 v116, -v97, v148, v116
    v_fma_f32 v148, v95, v148, v46
    v_fma_f32 v117, -v97, v149, v117
    v_fma_f32 v149, v95, v149, v47
    v_mul_f32 v46, v97, v118
    v_mul_f32 v118, v95, v118
    v_mul_f32 v47, v97, v119
    v_mul_f32 v119, v95, v119
    v_fma_f32 v118, -v97, v150, v118
    v_fma_f32 v150, v95, v150, v46
    v_fma_f32 v119, -v97, v151, v119
    v_fma_f32 v151, v95, v151, v47
    v_mul_f32 v46, v97, v120
    v_mul_f32 v120, v95, v120
    v_mul_f32 v47, v97, v121
    v_mul_f32 v121, v95, v121
    v_fma_f32 v120, -v97, v152, v120
    v_fma_f32 v152, v95, v152, v46
    v_fma_f32 v121, -v97, v153, v121
    v_fma_f32 v153, v95, v153, v47
    v_mul_f32 v46, v97, v122
    v_mul_f32 v122, v95, v122
    v_mul_f32 v47, v97, v123
    v_mul_f32 v123, v95, v123
    v_fma_f32 v122, -v97, v154, v122
    v_fma_f32 v154, v95, v154, v46
    v_fma_f32 v123, -v97, v155, v123
    v_fma_f32 v155, v95, v155, v47
    v_pk_mul_f32 v[46:47], v[96:97], v[124:125] op_sel:[1,0]
    v_pk_mul_f32 v[124:125], v[94:95], v[124:125] op_sel:[1,0]
    v_pk_fma_f32 v[124:125], v[96:97], v[156:157], v[124:125] op_sel:[1,0,0] neg_lo:[1,0,0] neg_hi:[1,0,0]
    v_pk_fma_f32 v[156:157], v[94:95], v[156:157], v[46:47] op_sel:[1,0,0]
    v_pk_mul_f32 v[46:47], v[96:97], v[126:127] op_sel:[1,0]
    v_pk_mul_f32 v[126:127], v[94:95], v[126:127] op_sel:[1,0]
    v_pk_fma_f32 v[126:127], v[96:97], v[158:159], v[126:127] op_sel:[1,0,0] neg_lo:[1,0,0] neg_hi:[1,0,0]
    v_pk_fma_f32 v[158:159], v[94:95], v[158:159], v[46:47] op_sel:[1,0,0]
    v_pk_mul_f32 v[46:47], v[96:97], v[128:129] op_sel:[1,0]
    v_pk_mul_f32 v[128:129], v[94:95], v[128:129] op_sel:[1,0]
    v_pk_fma_f32 v[128:129], v[96:97], v[160:161], v[128:129] op_sel:[1,0,0] neg_lo:[1,0,0] neg_hi:[1,0,0]
    v_pk_fma_f32 v[160:161], v[94:95], v[160:161], v[46:47] op_sel:[1,0,0]
    v_pk_mul_f32 v[46:47], v[96:97], v[130:131] op_sel:[1,0]
    v_pk_mul_f32 v[130:131], v[94:95], v[130:131] op_sel:[1,0]
    v_pk_fma_f32 v[130:131], v[96:97], v[162:163], v[130:131] op_sel:[1,0,0] neg_lo:[1,0,0] neg_hi:[1,0,0]
    v_pk_fma_f32 v[162:163], v[94:95], v[162:163], v[46:47] op_sel:[1,0,0]
    v_add_f32 v31, v28, v28
    v_and_b32 v9, 1, v0
    v_lshlrev_b32 v9, 4, v9
    v_sub_u32 v9, 16, v9
    v_lshrrev_b32 v31, v9, v31
    v_bfe_u32 v9, v5, 2, 1
    v_cmp_eq_u32 vcc, v9, v6
    s_nop 1
    v_cndmask_b32 v31, 0, v31, vcc
    v_lshrrev_b32 v9, 3, v5
    v_lshlrev_b32 v9, 1, v9
    v_bfe_u32 v172, v5, 1, 1
    v_or_b32 v9, v9, v172
    v_cmp_eq_u32 vcc, 0, v9
    s_nop 1
    v_cndmask_b32 v172, 0, v31, vcc
    v_cmp_eq_u32 vcc, 1, v9
    s_nop 1
    v_cndmask_b32 v173, 0, v31, vcc
    v_cmp_eq_u32 vcc, 2, v9
    s_nop 1
    v_cndmask_b32 v174, 0, v31, vcc
    v_cmp_eq_u32 vcc, 3, v9
    s_nop 1
    v_cndmask_b32 v175, 0, v31, vcc
    v_cmp_eq_u32 vcc, 4, v9
    s_nop 1
    v_cndmask_b32 v176, 0, v31, vcc
    v_cmp_eq_u32 vcc, 5, v9
    s_nop 1
    v_cndmask_b32 v177, 0, v31, vcc
    v_cmp_eq_u32 vcc, 6, v9
    s_nop 1
    v_cndmask_b32 v178, 0, v31, vcc
    v_cmp_eq_u32 vcc, 7, v9
    s_nop 1
    v_cndmask_b32 v179, 0, v31, vcc
    v_cvt_pk_bf16_f32 v208, v228, v229
    v_cvt_pk_bf16_f32 v209, v230, v231
    v_cvt_pk_bf16_f32 v210, v232, v233
    v_cvt_pk_bf16_f32 v211, v234, v235
    v_cvt_pk_bf16_f32 v212, v236, v237
    v_cvt_pk_bf16_f32 v213, v238, v239
    v_cvt_pk_bf16_f32 v214, v240, v241
    v_cvt_pk_bf16_f32 v215, v242, v243
    s_mul_i32 s86, s80, 8192
    s_add_u32 s86, s86, 32768
    v_add_u32 v56, s86, v35
    v_xor_b32 v57, 32, v56
    v_xor_b32 v58, 64, v56
    v_xor_b32 v59, 96, v56
    ds_read_b128 a[128:131], v56 offset:0
    ds_read_b128 a[132:135], v56 offset:4096
    ds_read_b128 a[136:139], v57 offset:0
    ds_read_b128 a[140:143], v57 offset:4096
    ds_read_b128 a[144:147], v58 offset:0
    ds_read_b128 a[148:151], v58 offset:4096
    ds_read_b128 a[152:155], v59 offset:0
    ds_read_b128 a[156:159], v59 offset:4096
gm_ck52:
    s_waitcnt vmcnt(8)
    v_max_u32 v62, v180, v184
    v_cmp_eq_u32 vcc, -1, v62
    s_nop 4
    s_cbranch_vccnz gm_rt54
gm_ok53:
    v_pk_fma_f32 v[184:185], v[86:87], v[180:181], v[184:185]
    v_pk_fma_f32 v[186:187], v[86:87], v[182:183], v[186:187]
    v_pk_fma_f32 v[184:185], v[88:89], v[182:183], v[184:185] neg_lo:[1,0,0] neg_hi:[1,0,0]
    v_pk_fma_f32 v[186:187], v[88:89], v[180:181], v[186:187]
    v_pk_mul_f32 v[188:189], v[90:91], v[184:185]
    v_pk_mul_f32 v[190:191], v[90:91], v[186:187]
    v_pk_fma_f32 v[188:189], v[92:93], v[186:187], v[188:189] neg_lo:[1,0,0] neg_hi:[1,0,0]
    v_pk_fma_f32 v[190:191], v[92:93], v[184:185], v[190:191]
    ds_write_b128 v16, v[188:191]
    s_waitcnt lgkmcnt(0)
    s_barrier
    ds_read_b128 v[180:183], v19 offset:0
    ds_read_b128 v[184:187], v19 offset:512
    ds_read_b128 v[188:191], v19 offset:1024
    ds_read_b128 v[192:195], v19 offset:1536
    ds_read_b128 v[196:199], v19 offset:2048
    ds_read_b128 v[200:203], v19 offset:2560
    ds_read_b128 v[204:207], v19 offset:3072
    ds_read_b128 v[24:27], v19 offset:3584
    s_mul_i32 s33, s80, 8192
    s_add_u32 m0, s33, 32768
    s_xor_b32 s32, s35, 1
    s_lshl_b32 s32, s32, 7
    s_add_u32 s32, s32, s36
    buffer_load_dwordx4 v3, s[68:71], s32 offen offset:0 lds
    s_add_u32 s32, s32, 7168
    buffer_load_dwordx4 v13, s[68:71], s32 offen offset:1024 lds
    s_add_u32 s32, s32, 7168
    buffer_load_dwordx4 v3, s[68:71], s32 offen offset:2048 lds
    s_add_u32 s32, s32, 7168
    buffer_load_dwordx4 v13, s[68:71], s32 offen offset:3072 lds
    s_waitcnt lgkmcnt(6)
    v_pk_add_f32 v[180:181], v[180:181], v[184:185]
    v_pk_add_f32 v[182:183], v[182:183], v[186:187]
    s_waitcnt lgkmcnt(4)
    v_pk_add_f32 v[188:189], v[188:189], v[192:193]
    v_pk_add_f32 v[190:191], v[190:191], v[194:195]
    s_waitcnt lgkmcnt(2)
    v_pk_add_f32 v[196:197], v[196:197], v[200:201]
    v_pk_add_f32 v[198:199], v[198:199], v[202:203]
    s_waitcnt lgkmcnt(0)
    v_pk_add_f32 v[204:205], v[204:205], v[24:25]
    v_pk_add_f32 v[206:207], v[206:207], v[26:27]
    v_pk_add_f32 v[180:181], v[180:181], v[188:189]
    v_pk_add_f32 v[182:183], v[182:183], v[190:191]
    v_pk_add_f32 v[196:197], v[196:197], v[204:205]
    v_pk_add_f32 v[198:199], v[198:199], v[206:207]
    v_pk_add_f32 v[180:181], v[180:181], v[196:197]
    v_pk_add_f32 v[182:183], v[182:183], v[198:199]
    v_pk_fma_f32 v[164:165], v[82:83], v[180:181], v[164:165]
    v_pk_fma_f32 v[166:167], v[82:83], v[182:183], v[166:167]
    v_pk_fma_f32 v[164:165], v[84:85], v[182:183], v[164:165] neg_lo:[1,0,0] neg_hi:[1,0,0]
    v_pk_fma_f32 v[166:167], v[84:85], v[180:181], v[166:167]
    v_mov_b32 v184, v164
    v_mov_b32 v186, v166
    v_fma_f32 v185, v74, v164, v168
    v_fma_f32 v187, v74, v166, v170
    v_mov_b32 v188, v165
    v_mov_b32 v190, v167
    v_fma_f32 v189, v75, v165, v169
    v_fma_f32 v191, v75, v167, v171
    v_fma_f32 v185, -v76, v166, v185
    v_fma_f32 v187, v76, v164, v187
    v_fma_f32 v189, -v77, v167, v189
    v_fma_f32 v191, v77, v165, v191
    v_pk_fma_f32 v[100:101], v[66:67], v[184:185], v[100:101] op_sel_hi:[0,1,1]
    v_pk_fma_f32 v[116:117], v[66:67], v[188:189], v[116:117] op_sel:[1,0,0]
    v_pk_fma_f32 v[132:133], v[66:67], v[186:187], v[132:133] op_sel_hi:[0,1,1]
    v_pk_fma_f32 v[148:149], v[66:67], v[190:191], v[148:149] op_sel:[1,0,0]
    v_pk_fma_f32 v[100:101], v[72:73], v[186:187], v[100:101] op_sel_hi:[0,1,1] neg_lo:[1,0,0] neg_hi:[1,0,0]
    v_pk_fma_f32 v[116:117], v[72:73], v[190:191], v[116:117] op_sel:[1,0,0] neg_lo:[1,0,0] neg_hi:[1,0,0]
    v_pk_fma_f32 v[132:133], v[72:73], v[184:185], v[132:133] op_sel_hi:[0,1,1]
    v_pk_fma_f32 v[148:149], v[72:73], v[188:189], v[148:149] op_sel:[1,0,0]
    s_add_u32 m0, s33, 36864
    s_add_u32 s32, s32, 11264
    buffer_load_dwordx4 v3, s[68:71], s32 offen offset:0 lds
    v_pk_fma_f32 v[102:103], v[66:67], v[100:101], v[102:103] op_sel_hi:[0,1,1]
    v_pk_fma_f32 v[118:119], v[66:67], v[116:117], v[118:119] op_sel:[1,0,0]
    v_pk_fma_f32 v[134:135], v[66:67], v[132:133], v[134:135] op_sel_hi:[0,1,1]
    v_pk_fma_f32 v[150:151], v[66:67], v[148:149], v[150:151] op_sel:[1,0,0]
    v_pk_fma_f32 v[102:103], v[72:73], v[132:133], v[102:103] op_sel_hi:[0,1,1] neg_lo:[1,0,0] neg_hi:[1,0,0]
    v_pk_fma_f32 v[118:119], v[72:73], v[148:149], v[118:119] op_sel:[1,0,0] neg_lo:[1,0,0] neg_hi:[1,0,0]
    v_pk_fma_f32 v[134:135], v[72:73], v[100:101], v[134:135] op_sel_hi:[0,1,1]
    v_pk_fma_f32 v[150:151], v[72:73], v[116:117], v[150:151] op_sel:[1,0,0]
    s_add_u32 s32, s32, 7168
    buffer_load_dwordx4 v13, s[68:71], s32 offen offset:1024 lds
    v_pk_fma_f32 v[104:105], v[66:67], v[102:103], v[104:105] op_sel_hi:[0,1,1]
    v_pk_fma_f32 v[120:121], v[66:67], v[118:119], v[120:121] op_sel:[1,0,0]
    v_pk_fma_f32 v[136:137], v[66:67], v[134:135], v[136:137] op_sel_hi:[0,1,1]
    v_pk_fma_f32 v[152:153], v[66:67], v[150:151], v[152:153] op_sel:[1,0,0]
    v_pk_fma_f32 v[104:105], v[72:73], v[134:135], v[104:105] op_sel_hi:[0,1,1] neg_lo:[1,0,0] neg_hi:[1,0,0]
    v_pk_fma_f32 v[120:121], v[72:73], v[150:151], v[120:121] op_sel:[1,0,0] neg_lo:[1,0,0] neg_hi:[1,0,0]
    v_pk_fma_f32 v[136:137], v[72:73], v[102:103], v[136:137] op_sel_hi:[0,1,1]
    v_pk_fma_f32 v[152:153], v[72:73], v[118:119], v[152:153] op_sel:[1,0,0]
    s_add_u32 s32, s32, 7168
    buffer_load_dwordx4 v3, s[68:71], s32 offen offset:2048 lds
    v_pk_fma_f32 v[106:107], v[66:67], v[104:105], v[106:107] op_sel_hi:[0,1,1]
    v_pk_fma_f32 v[122:123], v[66:67], v[120:121], v[122:123] op_sel:[1,0,0]
    v_pk_fma_f32 v[138:139], v[66:67], v[136:137], v[138:139] op_sel_hi:[0,1,1]
    v_pk_fma_f32 v[154:155], v[66:67], v[152:153], v[154:155] op_sel:[1,0,0]
    v_pk_fma_f32 v[106:107], v[72:73], v[136:137], v[106:107] op_sel_hi:[0,1,1] neg_lo:[1,0,0] neg_hi:[1,0,0]
    v_pk_fma_f32 v[122:123], v[72:73], v[152:153], v[122:123] op_sel:[1,0,0] neg_lo:[1,0,0] neg_hi:[1,0,0]
    v_pk_fma_f32 v[138:139], v[72:73], v[104:105], v[138:139] op_sel_hi:[0,1,1]
    v_pk_fma_f32 v[154:155], v[72:73], v[120:121], v[154:155] op_sel:[1,0,0]
    s_add_u32 s32, s32, 7168
    buffer_load_dwordx4 v13, s[68:71], s32 offen offset:3072 lds
    v_pk_fma_f32 v[108:109], v[66:67], v[106:107], v[108:109] op_sel_hi:[0,1,1]
    v_pk_fma_f32 v[124:125], v[66:67], v[122:123], v[124:125] op_sel:[1,0,0]
    v_pk_fma_f32 v[140:141], v[66:67], v[138:139], v[140:141] op_sel_hi:[0,1,1]
    v_pk_fma_f32 v[156:157], v[66:67], v[154:155], v[156:157] op_sel:[1,0,0]
    v_pk_fma_f32 v[108:109], v[72:73], v[138:139], v[108:109] op_sel_hi:[0,1,1] neg_lo:[1,0,0] neg_hi:[1,0,0]
    v_pk_fma_f32 v[124:125], v[72:73], v[154:155], v[124:125] op_sel:[1,0,0] neg_lo:[1,0,0] neg_hi:[1,0,0]
    v_pk_fma_f32 v[140:141], v[72:73], v[106:107], v[140:141] op_sel_hi:[0,1,1]
    v_pk_fma_f32 v[156:157], v[72:73], v[122:123], v[156:157] op_sel:[1,0,0]
    v_pk_fma_f32 v[110:111], v[66:67], v[108:109], v[110:111] op_sel_hi:[0,1,1]
    v_pk_fma_f32 v[126:127], v[66:67], v[124:125], v[126:127] op_sel:[1,0,0]
    v_pk_fma_f32 v[142:143], v[66:67], v[140:141], v[142:143] op_sel_hi:[0,1,1]
    v_pk_fma_f32 v[158:159], v[66:67], v[156:157], v[158:159] op_sel:[1,0,0]
    v_pk_fma_f32 v[110:111], v[72:73], v[140:141], v[110:111] op_sel_hi:[0,1,1] neg_lo:[1,0,0] neg_hi:[1,0,0]
    v_pk_fma_f32 v[126:127], v[72:73], v[156:157], v[126:127] op_sel:[1,0,0] neg_lo:[1,0,0] neg_hi:[1,0,0]
    v_pk_fma_f32 v[142:143], v[72:73], v[108:109], v[142:143] op_sel_hi:[0,1,1]
    v_pk_fma_f32 v[158:159], v[72:73], v[124:125], v[158:159] op_sel:[1,0,0]
    v_pk_fma_f32 v[112:113], v[66:67], v[110:111], v[112:113] op_sel_hi:[0,1,1]
    v_pk_fma_f32 v[128:129], v[66:67], v[126:127], v[128:129] op_sel:[1,0,0]
    v_pk_fma_f32 v[144:145], v[66:67], v[142:143], v[144:145] op_sel_hi:[0,1,1]
    v_pk_fma_f32 v[160:161], v[66:67], v[158:159], v[160:161] op_sel:[1,0,0]
    v_pk_fma_f32 v[112:113], v[72:73], v[142:143], v[112:113] op_sel_hi:[0,1,1] neg_lo:[1,0,0] neg_hi:[1,0,0]
    v_pk_fma_f32 v[128:129], v[72:73], v[158:159], v[128:129] op_sel:[1,0,0] neg_lo:[1,0,0] neg_hi:[1,0,0]
    v_pk_fma_f32 v[144:145], v[72:73], v[110:111], v[144:145] op_sel_hi:[0,1,1]
    v_pk_fma_f32 v[160:161], v[72:73], v[126:127], v[160:161] op_sel:[1,0,0]
    v_pk_fma_f32 v[114:115], v[66:67], v[112:113], v[114:115] op_sel_hi:[0,1,1]
    v_pk_fma_f32 v[130:131], v[66:67], v[128:129], v[130:131] op_sel:[1,0,0]
    v_pk_fma_f32 v[146:147], v[66:67], v[144:145], v[146:147] op_sel_hi:[0,1,1]
    v_pk_fma_f32 v[162:163], v[66:67], v[160:161], v[162:163] op_sel:[1,0,0]
    v_pk_fma_f32 v[114:115], v[72:73], v[144:145], v[114:115] op_sel_hi:[0,1,1] neg_lo:[1,0,0] neg_hi:[1,0,0]
    v_pk_fma_f32 v[130:131], v[72:73], v[160:161], v[130:131] op_sel:[1,0,0] neg_lo:[1,0,0] neg_hi:[1,0,0]
    v_pk_fma_f32 v[146:147], v[72:73], v[112:113], v[146:147] op_sel_hi:[0,1,1]
    v_pk_fma_f32 v[162:163], v[72:73], v[128:129], v[162:163] op_sel:[1,0,0]
    s_lshl_b32 s38, s82, 13
    s_add_u32 s38, s38, s24
    s_add_u32 s39, s38, 4096
    v_cvt_pk_bf16_f32 v44, v100, v101
    v_cvt_pk_bf16_f32 v45, v102, v103
    v_cvt_pk_bf16_f32 v46, v104, v105
    v_cvt_pk_bf16_f32 v47, v106, v107
    v_cvt_pk_bf16_f32 v48, v108, v109
    v_cvt_pk_bf16_f32 v49, v110, v111
    v_cvt_pk_bf16_f32 v50, v112, v113
    v_cvt_pk_bf16_f32 v51, v114, v115
    v_mfma_f32_32x32x16_bf16 v[100:115], v[44:47], v[172:175], 0
    s_nop 0
    v_mfma_f32_32x32x16_bf16 v[100:115], v[48:51], v[176:179], v[100:115]
    v_cvt_pk_bf16_f32 v164, v116, v117
    v_cvt_pk_bf16_f32 v165, v118, v119
    v_cvt_pk_bf16_f32 v166, v120, v121
    v_cvt_pk_bf16_f32 v167, v122, v123
    v_cvt_pk_bf16_f32 v168, v124, v125
    v_cvt_pk_bf16_f32 v169, v126, v127
    v_cvt_pk_bf16_f32 v170, v128, v129
    v_cvt_pk_bf16_f32 v171, v130, v131
    v_mfma_f32_32x32x16_bf16 v[116:131], v[164:167], v[172:175], 0
    s_nop 0
    v_mfma_f32_32x32x16_bf16 v[116:131], v[168:171], v[176:179], v[116:131]
    v_cvt_pk_bf16_f32 v180, -v132, -v133
    v_cvt_pk_bf16_f32 v181, -v134, -v135
    v_cvt_pk_bf16_f32 v182, -v136, -v137
    v_cvt_pk_bf16_f32 v183, -v138, -v139
    v_cvt_pk_bf16_f32 v184, -v140, -v141
    v_cvt_pk_bf16_f32 v185, -v142, -v143
    v_cvt_pk_bf16_f32 v186, -v144, -v145
    v_cvt_pk_bf16_f32 v187, -v146, -v147
    v_mfma_f32_32x32x16_bf16 v[132:147], v[180:183], v[172:175], 0
    s_nop 0
    v_mfma_f32_32x32x16_bf16 v[132:147], v[184:187], v[176:179], v[132:147]
    v_cvt_pk_bf16_f32 v188, -v148, -v149
    v_cvt_pk_bf16_f32 v189, -v150, -v151
    v_cvt_pk_bf16_f32 v190, -v152, -v153
    v_cvt_pk_bf16_f32 v191, -v154, -v155
    v_cvt_pk_bf16_f32 v192, -v156, -v157
    v_cvt_pk_bf16_f32 v193, -v158, -v159
    v_cvt_pk_bf16_f32 v194, -v160, -v161
    v_cvt_pk_bf16_f32 v195, -v162, -v163
    v_mfma_f32_32x32x16_bf16 v[148:163], v[188:191], v[172:175], 0
    s_nop 0
    v_mfma_f32_32x32x16_bf16 v[148:163], v[192:195], v[176:179], v[148:163]
    v_cvt_pk_bf16_f32 v44, v100, v101
    v_cvt_pk_bf16_f32 v45, v102, v103
    v_cvt_pk_bf16_f32 v46, v104, v105
    v_cvt_pk_bf16_f32 v47, v106, v107
    v_cvt_pk_bf16_f32 v48, v108, v109
    v_cvt_pk_bf16_f32 v49, v110, v111
    v_cvt_pk_bf16_f32 v50, v112, v113
    v_cvt_pk_bf16_f32 v51, v114, v115
    buffer_store_dwordx4 v[44:47], v18, s[56:59], s38 offen offset:0 sc1
    buffer_store_dwordx4 v[48:51], v18, s[56:59], s38 offen offset:1024 sc1
    v_cvt_pk_bf16_f32 v164, v116, v117
    v_cvt_pk_bf16_f32 v165, v118, v119
    v_cvt_pk_bf16_f32 v166, v120, v121
    v_cvt_pk_bf16_f32 v167, v122, v123
    v_cvt_pk_bf16_f32 v168, v124, v125
    v_cvt_pk_bf16_f32 v169, v126, v127
    v_cvt_pk_bf16_f32 v170, v128, v129
    v_cvt_pk_bf16_f32 v171, v130, v131
    buffer_store_dwordx4 v[164:167], v18, s[56:59], s38 offen offset:2048 sc1
    buffer_store_dwordx4 v[168:171], v18, s[56:59], s38 offen offset:3072 sc1
    v_cvt_pk_bf16_f32 v180, v132, v133
    v_cvt_pk_bf16_f32 v181, v134, v135
    v_cvt_pk_bf16_f32 v182, v136, v137
    v_cvt_pk_bf16_f32 v183, v138, v139
    v_cvt_pk_bf16_f32 v184, v140, v141
    v_cvt_pk_bf16_f32 v185, v142, v143
    v_cvt_pk_bf16_f32 v186, v144, v145
    v_cvt_pk_bf16_f32 v187, v146, v147
    buffer_store_dwordx4 v[180:183], v18, s[56:59], s39 offen offset:0 sc1
    buffer_store_dwordx4 v[184:187], v18, s[56:59], s39 offen offset:1024 sc1
    v_cvt_pk_bf16_f32 v188, v148, v149
    v_cvt_pk_bf16_f32 v189, v150, v151
    v_cvt_pk_bf16_f32 v190, v152, v153
    v_cvt_pk_bf16_f32 v191, v154, v155
    v_cvt_pk_bf16_f32 v192, v156, v157
    v_cvt_pk_bf16_f32 v193, v158, v159
    v_cvt_pk_bf16_f32 v194, v160, v161
    v_cvt_pk_bf16_f32 v195, v162, v163
    buffer_store_dwordx4 v[188:191], v18, s[56:59], s39 offen offset:2048 sc1
    buffer_store_dwordx4 v[192:195], v18, s[56:59], s39 offen offset:3072 sc1
    s_lshl_b32 s39, s82, 2
    s_lshr_b32 s38, s80, 1
    s_add_u32 s39, s39, s38
    s_add_u32 s39, s39, 2
    s_lshl_b32 s88, s39, 10
    s_add_u32 s88, s88, 589824
    s_lshl_b32 s87, s39, 14
    s_and_b32 s39, s80, 1
    s_lshl_b32 s39, s39, 9
    s_add_u32 s87, s87, s39
    s_add_u32 s87, s87, 65536
    v_lshlrev_b32 v11, 10, v6
    v_and_b32 v9, 1, v7
    v_lshl_add_u32 v11, v9, 8, v11
    v_lshl_add_u32 v11, v8, 4, v11
    v_add_u32 v11, s87, v11
    v_and_b32 v10, 7, v0
    v_lshlrev_b32 v10, 7, v10
    v_lshl_add_u32 v10, v6, 6, v10
    v_lshl_add_u32 v10, v9, 4, v10
    v_bfe_u32 v4, v0, 3, 1
    v_lshl_add_u32 v10, v4, 5, v10
    v_add_u32 v10, s88, v10
    s_mul_i32 s38, s38, 1088
    s_add_u32 s38, s38, 159744
    s_add_u32 s39, s39, s38
    v_lshlrev_b32 v14, 8, v6
    v_lshl_add_u32 v14, v8, 4, v14
    v_lshl_add_u32 v14, v9, 3, v14
    v_add_u32 v14, s39, v14
    v_lshlrev_b32 v4, 5, v4
    v_lshl_add_u32 v15, v7, 3, v4
    s_add_u32 s38, s38, 1024
    v_add_u32 v15, s38, v15
    v_lshlrev_b32 v4, 9, v6
    v_lshl_add_u32 v4, v5, 4, v4
    v_lshlrev_b32 v9, 5, v6
    v_add_u32 v9, 1024, v9
    v_cmp_gt_u32 vcc, 16, v5
    s_nop 1
    v_cndmask_b32 v16, v9, v4, vcc
    v_mov_b32 v4, 256
    v_cndmask_b32 v4, 16, v4, vcc
    v_add_u32 v16, 159744, v16
    v_add_u32 v19, v16, v4
    buffer_load_dwordx4 v[84:87], v10, s[56:59], 0 offen sc1
    buffer_load_dwordx4 v[20:23], v11, s[56:59], 0 offen offset:0 sc1
    buffer_load_dwordx4 v[24:27], v11, s[56:59], 0 offen offset:2048 sc1
    s_mov_b32 s38, 4096
    buffer_load_dwordx4 v[44:47], v11, s[56:59], s38 offen offset:0 sc1
    buffer_load_dwordx4 v[48:51], v11, s[56:59], s38 offen offset:2048 sc1
    s_mov_b32 s38, 8192
    buffer_load_dwordx4 v[64:67], v11, s[56:59], s38 offen offset:0 sc1
    buffer_load_dwordx4 v[72:75], v11, s[56:59], s38 offen offset:2048 sc1
    s_mov_b32 s38, 12288
    buffer_load_dwordx4 v[76:79], v11, s[56:59], s38 offen offset:0 sc1
    buffer_load_dwordx4 v[80:83], v11, s[56:59], s38 offen offset:2048 sc1
    s_mov_b32 s39, 5120
    buffer_load_dwordx4 v[88:91], v18, s[56:59], s39 offen sc1
    s_mul_i32 s86, s80, 16384
    s_add_u32 s86, s86, 65536
    v_add_u32 v56, s86, v35
    v_xor_b32 v57, 32, v56
    v_xor_b32 v58, 64, v56
    v_xor_b32 v59, 96, v56
    ds_read_b128 a[160:163], v56 offset:0
    ds_read_b128 a[164:167], v56 offset:4096
    ds_read_b128 a[168:171], v57 offset:0
    ds_read_b128 a[172:175], v57 offset:4096
    ds_read_b128 a[176:179], v58 offset:0
    ds_read_b128 a[180:183], v58 offset:4096
    ds_read_b128 a[184:187], v59 offset:0
    ds_read_b128 a[188:191], v59 offset:4096
    s_waitcnt vmcnt(26)
    s_mul_i32 s86, s80, 16384
    s_add_u32 s86, s86, 73728
    v_add_u32 v56, s86, v35
    v_xor_b32 v57, 32, v56
    v_xor_b32 v58, 64, v56
    v_xor_b32 v59, 96, v56
    ds_read_b128 a[192:195], v56 offset:0
    ds_read_b128 a[196:199], v56 offset:4096
    ds_read_b128 a[200:203], v57 offset:0
    ds_read_b128 a[204:207], v57 offset:4096
    ds_read_b128 a[208:211], v58 offset:0
    ds_read_b128 a[212:215], v58 offset:4096
    ds_read_b128 a[216:219], v59 offset:0
    ds_read_b128 a[220:223], v59 offset:4096
    v_mfma_f32_32x32x16_bf16 v[92:107], v[220:223], v[208:211], 0
    v_mfma_f32_32x32x16_bf16 v[108:123], v[224:227], v[212:215], 0
    s_nop 10
    v_max3_f32 v124, v92, v93, v94
    v_max3_f32 v125, v95, v96, v97
    v_max3_f32 v124, v124, v98, v99
    v_max3_f32 v125, v125, v100, v101
    v_max3_f32 v124, v124, v102, v103
    v_max3_f32 v125, v125, v104, v105
    v_max3_f32 v124, v124, v106, v107
    v_max_f32 v124, v124, v125
    v_mul_f32 v124, 3216550459, v124
    s_waitcnt lgkmcnt(0)
    v_pk_fma_f32 v[92:93], v[92:93], s[96:97], v[124:125] op_sel_hi:[1,1,0]
    s_mul_i32 s33, s80, 16384
    s_add_u32 m0, s33, 65536
    s_xor_b32 s32, s35, 0
    s_lshl_b32 s32, s32, 16
    s_add_u32 s32, s32, s37
    buffer_load_dwordx4 v55, s[60:63], s32 offen offset:0 lds
    v_pk_fma_f32 v[94:95], v[94:95], s[96:97], v[124:125] op_sel_hi:[1,1,0]
    v_pk_fma_f32 v[96:97], v[96:97], s[96:97], v[124:125] op_sel_hi:[1,1,0]
    v_pk_fma_f32 v[98:99], v[98:99], s[96:97], v[124:125] op_sel_hi:[1,1,0]
    v_pk_fma_f32 v[100:101], v[100:101], s[96:97], v[124:125] op_sel_hi:[1,1,0]
    v_pk_fma_f32 v[102:103], v[102:103], s[96:97], v[124:125] op_sel_hi:[1,1,0]
    s_add_u32 s32, s32, 7168
    buffer_load_dwordx4 v55, s[60:63], s32 offen offset:1024 lds
    v_pk_fma_f32 v[104:105], v[104:105], s[96:97], v[124:125] op_sel_hi:[1,1,0]
    v_pk_fma_f32 v[106:107], v[106:107], s[96:97], v[124:125] op_sel_hi:[1,1,0]
    v_exp_f32 v92, v92
    v_exp_f32 v93, v93
    v_exp_f32 v94, v94
    s_add_u32 s32, s32, 7168
    buffer_load_dwordx4 v55, s[60:63], s32 offen offset:2048 lds
    v_exp_f32 v95, v95
    v_exp_f32 v96, v96
    v_exp_f32 v97, v97
    v_exp_f32 v98, v98
    v_exp_f32 v99, v99
    s_add_u32 s32, s32, 7168
    buffer_load_dwordx4 v55, s[60:63], s32 offen offset:3072 lds
    v_exp_f32 v100, v100
    v_exp_f32 v101, v101
    v_exp_f32 v102, v102
    v_exp_f32 v103, v103
    v_exp_f32 v104, v104
    s_add_u32 m0, s33, 69632
    s_add_u32 s32, s32, 11264
    buffer_load_dwordx4 v55, s[60:63], s32 offen offset:0 lds
    v_exp_f32 v105, v105
    v_exp_f32 v106, v106
    v_exp_f32 v107, v107
    v_pk_add_f32 v[126:127], v[92:93], v[94:95]
    v_pk_add_f32 v[124:125], v[96:97], v[98:99]
    s_add_u32 s32, s32, 7168
    buffer_load_dwordx4 v55, s[60:63], s32 offen offset:1024 lds
    v_pk_add_f32 v[126:127], v[126:127], v[100:101]
    v_pk_add_f32 v[124:125], v[124:125], v[102:103]
    v_pk_add_f32 v[126:127], v[126:127], v[104:105]
    v_pk_add_f32 v[124:125], v[124:125], v[106:107]
    v_pk_add_f32 v[126:127], v[126:127], v[124:125]
    s_add_u32 s32, s32, 7168
    buffer_load_dwordx4 v55, s[60:63], s32 offen offset:2048 lds
    v_add_f32 v126, v126, v127
    v_rcp_f32 v126, v126
    s_nop 0
    v_pk_mul_f32 v[92:93], v[92:93], v[126:127] op_sel_hi:[1,0]
    v_pk_mul_f32 v[94:95], v[94:95], v[126:127] op_sel_hi:[1,0]
    v_pk_mul_f32 v[96:97], v[96:97], v[126:127] op_sel_hi:[1,0]
    s_add_u32 s32, s32, 7168
    buffer_load_dwordx4 v55, s[60:63], s32 offen offset:3072 lds
    v_pk_mul_f32 v[98:99], v[98:99], v[126:127] op_sel_hi:[1,0]
    v_pk_mul_f32 v[100:101], v[100:101], v[126:127] op_sel_hi:[1,0]
    v_pk_mul_f32 v[102:103], v[102:103], v[126:127] op_sel_hi:[1,0]
    v_pk_mul_f32 v[104:105], v[104:105], v[126:127] op_sel_hi:[1,0]
    v_pk_mul_f32 v[106:107], v[106:107], v[126:127] op_sel_hi:[1,0]
    s_mul_i32 s33, s80, 16384
    s_add_u32 m0, s33, 73728
    s_xor_b32 s32, s35, 1
    s_lshl_b32 s32, s32, 16
    s_add_u32 s32, s32, s37
    buffer_load_dwordx4 v55, s[60:63], s32 offen offset:0 lds
    v_cvt_pk_bf16_f32 v208, v92, v93
    v_cvt_pk_bf16_f32 v209, v94, v95
    v_cvt_pk_bf16_f32 v210, v96, v97
    v_cvt_pk_bf16_f32 v211, v98, v99
    v_cvt_pk_bf16_f32 v212, v100, v101
    s_add_u32 s32, s32, 7168
    buffer_load_dwordx4 v55, s[60:63], s32 offen offset:1024 lds
    v_cvt_pk_bf16_f32 v213, v102, v103
    v_cvt_pk_bf16_f32 v214, v104, v105
    v_cvt_pk_bf16_f32 v215, v106, v107
    v_max3_f32 v124, v108, v109, v110
    v_max3_f32 v125, v111, v112, v113
    s_add_u32 s32, s32, 7168
    buffer_load_dwordx4 v55, s[60:63], s32 offen offset:2048 lds
    v_max3_f32 v124, v124, v114, v115
    v_max3_f32 v125, v125, v116, v117
    v_max3_f32 v124, v124, v118, v119
    v_max3_f32 v125, v125, v120, v121
    v_max3_f32 v124, v124, v122, v123
    s_add_u32 s32, s32, 7168
    buffer_load_dwordx4 v55, s[60:63], s32 offen offset:3072 lds
    v_max_f32 v124, v124, v125
    v_mul_f32 v124, 3216550459, v124
    v_pk_fma_f32 v[108:109], v[108:109], s[96:97], v[124:125] op_sel_hi:[1,1,0]
    v_pk_fma_f32 v[110:111], v[110:111], s[96:97], v[124:125] op_sel_hi:[1,1,0]
    v_pk_fma_f32 v[112:113], v[112:113], s[96:97], v[124:125] op_sel_hi:[1,1,0]
    s_add_u32 m0, s33, 77824
    s_add_u32 s32, s32, 11264
    buffer_load_dwordx4 v55, s[60:63], s32 offen offset:0 lds
    v_pk_fma_f32 v[114:115], v[114:115], s[96:97], v[124:125] op_sel_hi:[1,1,0]
    v_pk_fma_f32 v[116:117], v[116:117], s[96:97], v[124:125] op_sel_hi:[1,1,0]
    v_pk_fma_f32 v[118:119], v[118:119], s[96:97], v[124:125] op_sel_hi:[1,1,0]
    v_pk_fma_f32 v[120:121], v[120:121], s[96:97], v[124:125] op_sel_hi:[1,1,0]
    v_pk_fma_f32 v[122:123], v[122:123], s[96:97], v[124:125] op_sel_hi:[1,1,0]
    s_add_u32 s32, s32, 7168
    buffer_load_dwordx4 v55, s[60:63], s32 offen offset:1024 lds
    v_exp_f32 v108, v108
    v_exp_f32 v109, v109
    v_exp_f32 v110, v110
    v_exp_f32 v111, v111
    v_exp_f32 v112, v112
    s_add_u32 s32, s32, 7168
    buffer_load_dwordx4 v55, s[60:63], s32 offen offset:2048 lds
    v_exp_f32 v113, v113
    v_exp_f32 v114, v114
    v_exp_f32 v115, v115
    v_exp_f32 v116, v116
    v_exp_f32 v117, v117
    s_add_u32 s32, s32, 7168
    buffer_load_dwordx4 v55, s[60:63], s32 offen offset:3072 lds
    v_exp_f32 v118, v118
    v_exp_f32 v119, v119
    v_exp_f32 v120, v120
    v_exp_f32 v121, v121
    v_exp_f32 v122, v122
    v_exp_f32 v123, v123
    v_pk_add_f32 v[126:127], v[108:109], v[110:111]
    v_pk_add_f32 v[124:125], v[112:113], v[114:115]
    v_pk_add_f32 v[126:127], v[126:127], v[116:117]
    v_pk_add_f32 v[124:125], v[124:125], v[118:119]
    v_pk_add_f32 v[126:127], v[126:127], v[120:121]
    v_pk_add_f32 v[124:125], v[124:125], v[122:123]
    v_pk_add_f32 v[126:127], v[126:127], v[124:125]
    v_add_f32 v126, v126, v127
    v_rcp_f32 v126, v126
    s_nop 0
    v_pk_mul_f32 v[108:109], v[108:109], v[126:127] op_sel_hi:[1,0]
    v_pk_mul_f32 v[110:111], v[110:111], v[126:127] op_sel_hi:[1,0]
    v_pk_mul_f32 v[112:113], v[112:113], v[126:127] op_sel_hi:[1,0]
    v_pk_mul_f32 v[114:115], v[114:115], v[126:127] op_sel_hi:[1,0]
    v_pk_mul_f32 v[116:117], v[116:117], v[126:127] op_sel_hi:[1,0]
    v_pk_mul_f32 v[118:119], v[118:119], v[126:127] op_sel_hi:[1,0]
    v_pk_mul_f32 v[120:121], v[120:121], v[126:127] op_sel_hi:[1,0]
    v_pk_mul_f32 v[122:123], v[122:123], v[126:127] op_sel_hi:[1,0]
    v_cvt_pk_bf16_f32 v128, v108, v109
    v_cvt_pk_bf16_f32 v129, v110, v111
    v_cvt_pk_bf16_f32 v130, v112, v113
    v_cvt_pk_bf16_f32 v131, v114, v115
    v_cvt_pk_bf16_f32 v132, v116, v117
    v_cvt_pk_bf16_f32 v133, v118, v119
    v_cvt_pk_bf16_f32 v134, v120, v121
    v_cvt_pk_bf16_f32 v135, v122, v123
    s_mov_b32 s76, s28
    s_and_b32 s77, s29, 0xffff
    s_mov_b32 s78, 1024
    s_mov_b32 s79, 0x20000
    v_and_b32 v4, 1, v7
    v_lshlrev_b32 v4, 3, v4
    v_or_b32 v28, v4, v6
    v_lshlrev_b32 v9, 3, v8
    v_lshl_add_u32 v4, v28, 10, v9
    s_lshl_b32 s38, s80, 1
    s_add_u32 s90, s38, s95
    s_lshl_b32 s38, s90, 10
    s_lshl_b32 s39, s94, 1
    s_add_u32 s38, s38, s39
    buffer_load_dwordx2 v[94:95], v9, s[76:79], s39 offen
    s_add_u32 s39, s38, 0
    buffer_load_dwordx2 v[32:33], v4, s[40:43], s39 offen
    s_add_u32 s39, s38, 16384
    buffer_load_dwordx2 v[42:43], v4, s[40:43], s39 offen
    s_add_u32 s39, s38, 32768
    buffer_load_dwordx2 v[52:53], v4, s[40:43], s39 offen
    s_add_u32 s39, s38, 49152
    buffer_load_dwordx2 v[92:93], v4, s[40:43], s39 offen
    s_lshr_b32 s38, s95, 5
    s_mul_i32 s38, s38, 98304
    s_add_u32 s38, s38, 2097152
    s_lshl_b32 s39, s80, 14
    s_add_u32 s83, s38, s39
    s_lshl_b32 s39, s80, 13
    s_add_u32 s91, s38, s39
    s_add_u32 s91, s91, 65536
    s_lshl_b32 s39, s35, 13
    s_sub_u32 s85, s83, s39
    s_add_u32 s83, s83, s39
    s_lshl_b32 s39, s35, 12
    s_sub_u32 s3, s91, s39
    s_add_u32 s91, s91, s39
    s_waitcnt vmcnt(39)
    s_mul_i32 s86, s80, 8192
    s_add_u32 s86, s86, 32768
    v_add_u32 v56, s86, v35
    v_xor_b32 v57, 32, v56
    v_xor_b32 v58, 64, v56
    v_xor_b32 v59, 96, v56
    ds_read_b128 a[224:227], v56 offset:0
    ds_read_b128 a[228:231], v56 offset:4096
    ds_read_b128 a[232:235], v57 offset:0
    ds_read_b128 a[236:239], v57 offset:4096
    ds_read_b128 a[240:243], v58 offset:0
    ds_read_b128 a[244:247], v58 offset:4096
    ds_read_b128 a[248:251], v59 offset:0
    ds_read_b128 a[252:255], v59 offset:4096
gm_ck55:
    s_waitcnt vmcnt(27)
    v_max3_u32 v62, v20, v24, v44
    s_waitcnt vmcnt(25)
    v_max3_u32 v62, v62, v48, v64
    s_waitcnt vmcnt(23)
    v_max3_u32 v62, v62, v72, v76
    s_waitcnt vmcnt(22)
    v_max3_u32 v62, v62, v80, v84
    v_cmp_eq_u32 vcc, -1, v62
    s_nop 4
    s_cbranch_vccnz gm_rt57
gm_ok56:
    v_mfma_f32_16x16x32_bf16 v[100:103], v[68:71], v[84:87], 0
    v_mfma_f32_16x16x32_bf16 v[96:99], v[68:71], v[20:23], 0
    v_mfma_f32_16x16x32_bf16 v[96:99], v[68:71], v[24:27], v[96:99]
    v_mfma_f32_16x16x32_bf16 v[96:99], v[68:71], v[44:47], v[96:99]
    v_mfma_f32_16x16x32_bf16 v[96:99], v[68:71], v[48:51], v[96:99]
    v_mfma_f32_16x16x32_bf16 v[96:99], v[68:71], v[64:67], v[96:99]
    v_mfma_f32_16x16x32_bf16 v[96:99], v[68:71], v[72:75], v[96:99]
    v_mfma_f32_16x16x32_bf16 v[96:99], v[68:71], v[76:79], v[96:99]
    v_mfma_f32_16x16x32_bf16 v[96:99], v[68:71], v[80:83], v[96:99]
    v_add_f32 v100, v100, v100 quad_perm:[1,0,3,2] row_mask:0xf bank_mask:0xf
    v_add_f32 v101, v101, v101 quad_perm:[1,0,3,2] row_mask:0xf bank_mask:0xf
    v_add_f32 v102, v102, v102 quad_perm:[1,0,3,2] row_mask:0xf bank_mask:0xf
    v_add_f32 v103, v103, v103 quad_perm:[1,0,3,2] row_mask:0xf bank_mask:0xf
    v_add_f32 v100, v100, v100 quad_perm:[2,3,0,1] row_mask:0xf bank_mask:0xf
    v_add_f32 v101, v101, v101 quad_perm:[2,3,0,1] row_mask:0xf bank_mask:0xf
    v_add_f32 v102, v102, v102 quad_perm:[2,3,0,1] row_mask:0xf bank_mask:0xf
    v_add_f32 v103, v103, v103 quad_perm:[2,3,0,1] row_mask:0xf bank_mask:0xf
    v_add_f32 v100, v100, v100 row_half_mirror row_mask:0xf bank_mask:0xf
    v_add_f32 v101, v101, v101 row_half_mirror row_mask:0xf bank_mask:0xf
    v_add_f32 v102, v102, v102 row_half_mirror row_mask:0xf bank_mask:0xf
    v_add_f32 v103, v103, v103 row_half_mirror row_mask:0xf bank_mask:0xf
    v_cvt_pk_bf16_f32 v100, v100, v101
    v_cvt_pk_bf16_f32 v101, v102, v103
    ds_write_b64 v15, v[100:101]
    v_cvt_pk_bf16_f32 v96, v96, v97
    v_cvt_pk_bf16_f32 v97, v98, v99
    ds_write_b64 v14, v[96:97]
    s_lshl_b32 s89, s82, 12
    s_add_u32 s89, s89, s24
    s_add_u32 s89, s89, 67584
    s_waitcnt lgkmcnt(0)
    s_barrier
    ds_read_b128 v[20:23], v16 offset:0
    ds_read_b128 v[24:27], v19 offset:0
    ds_read_b128 v[44:47], v16 offset:1088
    ds_read_b128 v[48:51], v19 offset:1088
gm_ck58:
    s_waitcnt vmcnt(21)
    v_cmp_ne_u64 vcc, s[0:1], v[88:89]
    v_cmp_ne_u64 s[98:99], s[0:1], v[90:91]
    s_nop 3
    s_or_b64 vcc, vcc, s[98:99]
    s_cbranch_scc1 gm_rt60
gm_ok59:
    s_add_u32 s39, s83, 0
    buffer_load_dwordx4 v[88:91], v18, s[56:59], s39 offen offset:0 sc1
    buffer_load_dwordx4 v[120:123], v18, s[56:59], s39 offen offset:1024 sc1
    buffer_load_dwordx4 v[124:127], v18, s[56:59], s39 offen offset:2048 sc1
    buffer_load_dwordx4 v[152:155], v18, s[56:59], s39 offen offset:3072 sc1
    s_add_u32 s39, s83, 98304
    buffer_load_dwordx4 v[156:159], v18, s[56:59], s39 offen offset:0 sc1
    buffer_load_dwordx4 v[160:163], v18, s[56:59], s39 offen offset:1024 sc1
    buffer_load_dwordx4 v[164:167], v18, s[56:59], s39 offen offset:2048 sc1
    buffer_load_dwordx4 v[168:171], v18, s[56:59], s39 offen offset:3072 sc1
    s_waitcnt lgkmcnt(3)
    v_mfma_f32_32x32x16_bf16 v[104:119], v[20:23], v[208:211], 0
    s_waitcnt lgkmcnt(2)
    v_mfma_f32_32x32x16_bf16 v[104:119], v[24:27], v[212:215], v[104:119]
    s_waitcnt lgkmcnt(1)
    v_mfma_f32_32x32x16_bf16 v[136:151], v[44:47], v[128:131], 0
    s_waitcnt lgkmcnt(0)
    v_mfma_f32_32x32x16_bf16 v[136:151], v[48:51], v[132:135], v[136:151]
    s_nop 7
    v_add_f32 v112, 0x358637BD, v112
    v_rcp_f32 v112, v112
    s_nop 0
    v_mul_f32 v112, v112, v12
    v_pk_mul_f32 v[104:105], v[104:105], v[112:113] op_sel_hi:[1,0]
    v_pk_mul_f32 v[106:107], v[106:107], v[112:113] op_sel_hi:[1,0]
    v_pk_mul_f32 v[108:109], v[108:109], v[112:113] op_sel_hi:[1,0]
    v_pk_mul_f32 v[110:111], v[110:111], v[112:113] op_sel_hi:[1,0]
    v_cvt_pk_bf16_f32 v116, v104, v105
    v_cvt_pk_bf16_f32 v117, v106, v107
    v_cvt_pk_bf16_f32 v118, v108, v109
    v_cvt_pk_bf16_f32 v119, v110, v111
    buffer_store_dwordx4 v[116:119], v18, s[56:59], s89 offen offset:0 sc1
    v_add_f32 v144, 0x358637BD, v144
    v_rcp_f32 v144, v144
    s_nop 0
    v_mul_f32 v144, v144, v12
    v_pk_mul_f32 v[136:137], v[136:137], v[144:145] op_sel_hi:[1,0]
    v_pk_mul_f32 v[138:139], v[138:139], v[144:145] op_sel_hi:[1,0]
    v_pk_mul_f32 v[140:141], v[140:141], v[144:145] op_sel_hi:[1,0]
    v_pk_mul_f32 v[142:143], v[142:143], v[144:145] op_sel_hi:[1,0]
    v_cvt_pk_bf16_f32 v148, v136, v137
    v_cvt_pk_bf16_f32 v149, v138, v139
    v_cvt_pk_bf16_f32 v150, v140, v141
    v_cvt_pk_bf16_f32 v151, v142, v143
    buffer_store_dwordx4 v[148:151], v18, s[56:59], s89 offen offset:1024 sc1
    v_lshlrev_b32 v9, 2, v7
gm_ck61:
    s_waitcnt vmcnt(5)
    v_max3_u32 v62, v88, v120, v124
    s_waitcnt vmcnt(4)
    v_max_u32 v62, v62, v152
    v_cmp_eq_u32 vcc, -1, v62
    s_nop 4
    s_cbranch_vccnz gm_rt63
gm_ok62:
    v_mfma_f32_32x32x16_bf16 v[64:79], a[128:131], v[88:91], 0
    s_add_u32 s39, s83, 4096
    buffer_load_dwordx4 v[172:175], v18, s[56:59], s39 offen offset:0 sc1
    s_mul_i32 s86, s80, 16384
    s_add_u32 s86, s86, 65536
    v_add_u32 v56, s86, v37
    v_xor_b32 v57, 64, v56
    v_mfma_f32_32x32x16_bf16 v[128:143], a[132:135], v[88:91], 0
    buffer_load_dwordx4 v[176:179], v18, s[56:59], s39 offen offset:1024 sc1
    ds_read_b64_tr_b16 a[0:1], v56 offset:0
    ds_read_b64_tr_b16 a[2:3], v56 offset:512
    ds_read_b64_tr_b16 a[4:5], v57 offset:0
    ds_read_b64_tr_b16 a[6:7], v57 offset:512
    v_mfma_f32_32x32x16_bf16 v[64:79], a[136:139], v[120:123], v[64:79]
    buffer_load_dwordx4 v[180:183], v18, s[56:59], s39 offen offset:2048 sc1
    ds_read_b64_tr_b16 a[8:9], v56 offset:2048
    ds_read_b64_tr_b16 a[10:11], v56 offset:2560
    ds_read_b64_tr_b16 a[12:13], v57 offset:2048
    ds_read_b64_tr_b16 a[14:15], v57 offset:2560
    v_mfma_f32_32x32x16_bf16 v[128:143], a[140:143], v[120:123], v[128:143]
    buffer_load_dwordx4 v[184:187], v18, s[56:59], s39 offen offset:3072 sc1
    ds_read_b64_tr_b16 a[16:17], v56 offset:4096
    ds_read_b64_tr_b16 a[18:19], v56 offset:4608
    ds_read_b64_tr_b16 a[20:21], v57 offset:4096
    ds_read_b64_tr_b16 a[22:23], v57 offset:4608
    v_mfma_f32_32x32x16_bf16 v[64:79], a[144:147], v[124:127], v[64:79]
    ds_read_b64_tr_b16 a[24:25], v56 offset:6144
    ds_read_b64_tr_b16 a[26:27], v56 offset:6656
    ds_read_b64_tr_b16 a[28:29], v57 offset:6144
    ds_read_b64_tr_b16 a[30:31], v57 offset:6656
    s_mul_i32 s86, s80, 16384
    s_add_u32 s86, s86, 73728
    v_mfma_f32_32x32x16_bf16 v[128:143], a[148:151], v[124:127], v[128:143]
    v_add_u32 v56, s86, v37
    v_xor_b32 v57, 64, v56
    ds_read_b64_tr_b16 a[32:33], v56 offset:0
    ds_read_b64_tr_b16 a[34:35], v56 offset:512
    ds_read_b64_tr_b16 a[36:37], v57 offset:0
    v_mfma_f32_32x32x16_bf16 v[64:79], a[152:155], v[152:155], v[64:79]
gm_ck64:
    s_waitcnt vmcnt(5)
    v_max3_u32 v62, v156, v160, v164
    s_waitcnt vmcnt(4)
    v_max_u32 v62, v62, v168
    v_cmp_eq_u32 vcc, -1, v62
    s_nop 4
    s_cbranch_vccnz gm_rt66
gm_ok65:
    v_mfma_f32_32x32x16_bf16 v[128:143], a[156:159], v[152:155], v[128:143]
    v_mfma_f32_32x32x16_bf16 v[96:111], a[128:131], v[156:159], 0
    s_add_u32 s39, s83, 102400
    buffer_load_dwordx4 v[88:91], v18, s[56:59], s39 offen offset:0 sc1
    ds_read_b64_tr_b16 a[38:39], v57 offset:512
    ds_read_b64_tr_b16 a[40:41], v56 offset:2048
    ds_read_b64_tr_b16 a[42:43], v56 offset:2560
    v_mfma_f32_32x32x16_bf16 v[188:203], a[132:135], v[156:159], 0
    buffer_load_dwordx4 v[120:123], v18, s[56:59], s39 offen offset:1024 sc1
    ds_read_b64_tr_b16 a[44:45], v57 offset:2048
    ds_read_b64_tr_b16 a[46:47], v57 offset:2560
    ds_read_b64_tr_b16 a[48:49], v56 offset:4096
    ds_read_b64_tr_b16 a[50:51], v56 offset:4608
    v_mfma_f32_32x32x16_bf16 v[96:111], a[136:139], v[160:163], v[96:111]
    buffer_load_dwordx4 v[124:127], v18, s[56:59], s39 offen offset:2048 sc1
    ds_read_b64_tr_b16 a[52:53], v57 offset:4096
    ds_read_b64_tr_b16 a[54:55], v57 offset:4608
    ds_read_b64_tr_b16 a[56:57], v56 offset:6144
    ds_read_b64_tr_b16 a[58:59], v56 offset:6656
    v_mfma_f32_32x32x16_bf16 v[188:203], a[140:143], v[160:163], v[188:203]
    buffer_load_dwordx4 v[152:155], v18, s[56:59], s39 offen offset:3072 sc1
    ds_read_b64_tr_b16 a[60:61], v57 offset:6144
    ds_read_b64_tr_b16 a[62:63], v57 offset:6656
    v_lshlrev_b32 v80, 16, v94
    v_and_b32 v81, 0xffff0000, v94
    v_mfma_f32_32x32x16_bf16 v[96:111], a[144:147], v[164:167], v[96:111]
    v_lshlrev_b32 v82, 16, v95
    v_and_b32 v83, 0xffff0000, v95
    v_lshlrev_b32 v20, 16, v32
    v_and_b32 v21, 0xffff0000, v32
    v_lshlrev_b32 v22, 16, v33
    v_mfma_f32_32x32x16_bf16 v[188:203], a[148:151], v[164:167], v[188:203]
    v_and_b32 v23, 0xffff0000, v33
    v_mul_f32 v20, v20, v80
    v_mul_f32 v21, v21, v81
    v_mul_f32 v22, v22, v82
    v_mul_f32 v23, v23, v83
    v_mfma_f32_32x32x16_bf16 v[96:111], a[152:155], v[168:171], v[96:111]
gm_ck67:
    s_waitcnt vmcnt(5)
    v_max3_u32 v62, v172, v176, v180
    s_waitcnt vmcnt(4)
    v_max_u32 v62, v62, v184
    v_cmp_eq_u32 vcc, -1, v62
    s_nop 4
    s_cbranch_vccnz gm_rt69
gm_ok68:
    v_mfma_f32_32x32x16_bf16 v[188:203], a[156:159], v[168:171], v[188:203]
    v_mfma_f32_32x32x16_bf16 v[64:79], a[160:163], v[172:175], v[64:79]
    s_add_u32 s39, s85, 8192
    buffer_load_dwordx4 v[156:159], v18, s[56:59], s39 offen offset:0 sc1
    v_cvt_pk_bf16_f32 v32, v20, v21
    v_cvt_pk_bf16_f32 v33, v22, v23
    v_lshlrev_b32 v20, 16, v32
    v_mfma_f32_32x32x16_bf16 v[128:143], a[164:167], v[172:175], v[128:143]
    buffer_load_dwordx4 v[160:163], v18, s[56:59], s39 offen offset:1024 sc1
    v_and_b32 v21, 0xffff0000, v32
    v_lshlrev_b32 v22, 16, v33
    v_and_b32 v23, 0xffff0000, v33
    v_lshlrev_b32 v24, 16, v42
    v_mfma_f32_32x32x16_bf16 v[64:79], a[168:171], v[176:179], v[64:79]
    buffer_load_dwordx4 v[164:167], v18, s[56:59], s39 offen offset:2048 sc1
    v_and_b32 v25, 0xffff0000, v42
    v_lshlrev_b32 v26, 16, v43
    v_and_b32 v27, 0xffff0000, v43
    v_mul_f32 v24, v24, v80
    v_mfma_f32_32x32x16_bf16 v[128:143], a[172:175], v[176:179], v[128:143]
    buffer_load_dwordx4 v[168:171], v18, s[56:59], s39 offen offset:3072 sc1
    v_mul_f32 v25, v25, v81
    v_mul_f32 v26, v26, v82
    v_mul_f32 v27, v27, v83
    v_cvt_pk_bf16_f32 v42, v24, v25
    v_mfma_f32_32x32x16_bf16 v[64:79], a[176:179], v[180:183], v[64:79]
    s_lshr_b32 s88, s95, 6
    s_lshl_b32 s88, s88, 8
    s_lshl_b32 s89, s80, 5
    s_add_u32 s88, s88, s89
    s_add_u32 s88, s88, 720896
    buffer_load_dword v10, v9, s[56:59], s88 offen offset:0 sc1
    v_cvt_pk_bf16_f32 v43, v26, v27
    v_mfma_f32_32x32x16_bf16 v[128:143], a[180:183], v[180:183], v[128:143]
    buffer_load_dword v11, v9, s[56:59], s88 offen offset:16 sc1
    v_lshlrev_b32 v24, 16, v42
    v_and_b32 v25, 0xffff0000, v42
    v_lshlrev_b32 v26, 16, v43
    v_and_b32 v27, 0xffff0000, v43
    v_mfma_f32_32x32x16_bf16 v[64:79], a[184:187], v[184:187], v[64:79]
    buffer_load_dword v12, v9, s[56:59], s88 offen offset:128 sc1
gm_ck70:
    s_waitcnt vmcnt(8)
    v_max3_u32 v62, v88, v120, v124
    s_waitcnt vmcnt(7)
    v_max_u32 v62, v62, v152
    v_cmp_eq_u32 vcc, -1, v62
    s_nop 4
    s_cbranch_vccnz gm_rt72
gm_ok71:
    v_mfma_f32_32x32x16_bf16 v[128:143], a[188:191], v[184:187], v[128:143]
    buffer_load_dword v14, v9, s[56:59], s88 offen offset:144 sc1
    v_mfma_f32_32x32x16_bf16 v[96:111], a[160:163], v[88:91], v[96:111]
    s_add_u32 s39, s85, 106496
    buffer_load_dwordx4 v[172:175], v18, s[56:59], s39 offen offset:0 sc1
    v_lshlrev_b32 v44, 16, v52
    v_and_b32 v45, 0xffff0000, v52
    v_lshlrev_b32 v46, 16, v53
    v_mfma_f32_32x32x16_bf16 v[188:203], a[164:167], v[88:91], v[188:203]
    buffer_load_dwordx4 v[176:179], v18, s[56:59], s39 offen offset:1024 sc1
    v_and_b32 v47, 0xffff0000, v53
    v_mul_f32 v44, v44, v80
    v_mul_f32 v45, v45, v81
    v_mul_f32 v46, v46, v82
    v_mfma_f32_32x32x16_bf16 v[96:111], a[168:171], v[120:123], v[96:111]
    buffer_load_dwordx4 v[180:183], v18, s[56:59], s39 offen offset:2048 sc1
    v_mul_f32 v47, v47, v83
    v_cvt_pk_bf16_f32 v52, v44, v45
    v_cvt_pk_bf16_f32 v53, v46, v47
    v_lshlrev_b32 v44, 16, v52
    v_mfma_f32_32x32x16_bf16 v[188:203], a[172:175], v[120:123], v[188:203]
    buffer_load_dwordx4 v[184:187], v18, s[56:59], s39 offen offset:3072 sc1
    v_and_b32 v45, 0xffff0000, v52
    v_lshlrev_b32 v46, 16, v53
    v_and_b32 v47, 0xffff0000, v53
    v_lshlrev_b32 v48, 16, v92
    v_mfma_f32_32x32x16_bf16 v[96:111], a[176:179], v[124:127], v[96:111]
    v_and_b32 v49, 0xffff0000, v92
    v_lshlrev_b32 v50, 16, v93
    v_and_b32 v51, 0xffff0000, v93
    v_mul_f32 v48, v48, v80
    v_mul_f32 v49, v49, v81
    v_mfma_f32_32x32x16_bf16 v[188:203], a[180:183], v[124:127], v[188:203]
    v_mul_f32 v50, v50, v82
    v_mul_f32 v51, v51, v83
    v_cvt_pk_bf16_f32 v92, v48, v49
    v_cvt_pk_bf16_f32 v93, v50, v51
    v_lshlrev_b32 v48, 16, v92
    v_mfma_f32_32x32x16_bf16 v[96:111], a[184:187], v[152:155], v[96:111]
gm_ck73:
    s_waitcnt vmcnt(9)
    v_max3_u32 v62, v156, v160, v164
    s_waitcnt vmcnt(8)
    v_max_u32 v62, v62, v168
    v_cmp_eq_u32 vcc, -1, v62
    s_nop 4
    s_cbranch_vccnz gm_rt75
gm_ok74:
    v_mfma_f32_32x32x16_bf16 v[188:203], a[188:191], v[152:155], v[188:203]
    v_mfma_f32_32x32x16_bf16 v[64:79], a[192:195], v[156:159], v[64:79]
    s_add_u32 s39, s85, 12288
    buffer_load_dwordx4 v[88:91], v18, s[56:59], s39 offen offset:0 sc1
    v_and_b32 v49, 0xffff0000, v92
    v_lshlrev_b32 v50, 16, v93
    v_and_b32 v51, 0xffff0000, v93
    v_mfma_f32_32x32x16_bf16 v[128:143], a[196:199], v[156:159], v[128:143]
    buffer_load_dwordx4 v[120:123], v18, s[56:59], s39 offen offset:1024 sc1
    v_and_b32 v4, 7, v5
    v_xor_b32 v4, v4, v6
    v_lshlrev_b32 v4, 4, v4
    v_lshl_add_u32 v4, v5, 8, v4
    v_mfma_f32_32x32x16_bf16 v[64:79], a[200:203], v[160:163], v[64:79]
    buffer_load_dwordx4 v[124:127], v18, s[56:59], s39 offen offset:2048 sc1
    s_lshl_b32 s86, s80, 14
    s_add_u32 s86, s86, 65536
    v_add_u32 v15, s86, v4
    v_xor_b32 v16, 32, v15
    v_xor_b32 v19, 64, v15
    v_mfma_f32_32x32x16_bf16 v[128:143], a[204:207], v[160:163], v[128:143]
    buffer_load_dwordx4 v[152:155], v18, s[56:59], s39 offen offset:3072 sc1
    v_xor_b32 v29, 96, v15
    v_xor_b32 v4, v8, v7
    v_lshlrev_b32 v4, 4, v4
    v_lshl_add_u32 v4, v7, 8, v4
    v_mfma_f32_32x32x16_bf16 v[64:79], a[208:211], v[164:167], v[64:79]
    s_lshl_b32 s86, s80, 11
    s_add_u32 s86, s86, 65536
    v_add_u32 v31, s86, v4
    v_xor_b32 v34, 64, v31
    v_lshlrev_b32 v4, 4, v8
    v_lshl_add_u32 v41, v28, 11, v4
    v_mfma_f32_32x32x16_bf16 v[128:143], a[212:215], v[164:167], v[128:143]
    s_lshl_b32 s86, s90, 11
    s_lshl_b32 s87, s94, 2
    s_add_u32 s86, s86, s87
    v_mfma_f32_32x32x16_bf16 v[64:79], a[216:219], v[168:171], v[64:79]
gm_ck76:
    s_waitcnt vmcnt(5)
    v_max3_u32 v62, v172, v176, v180
    s_waitcnt vmcnt(4)
    v_max_u32 v62, v62, v184
    v_cmp_eq_u32 vcc, -1, v62
    s_nop 4
    s_cbranch_vccnz gm_rt78
gm_ok77:
    v_mfma_f32_32x32x16_bf16 v[128:143], a[220:223], v[168:171], v[128:143]
    v_mfma_f32_32x32x16_bf16 v[96:111], a[192:195], v[172:175], v[96:111]
    s_add_u32 s39, s85, 110592
    buffer_load_dwordx4 v[156:159], v18, s[56:59], s39 offen offset:0 sc1
    v_mfma_f32_32x32x16_bf16 v[188:203], a[196:199], v[172:175], v[188:203]
    buffer_load_dwordx4 v[160:163], v18, s[56:59], s39 offen offset:1024 sc1
    v_mfma_f32_32x32x16_bf16 v[96:111], a[200:203], v[176:179], v[96:111]
    buffer_load_dwordx4 v[164:167], v18, s[56:59], s39 offen offset:2048 sc1
    v_mfma_f32_32x32x16_bf16 v[188:203], a[204:207], v[176:179], v[188:203]
    buffer_load_dwordx4 v[168:171], v18, s[56:59], s39 offen offset:3072 sc1
    v_mfma_f32_32x32x16_bf16 v[96:111], a[208:211], v[180:183], v[96:111]
    v_mfma_f32_32x32x16_bf16 v[188:203], a[212:215], v[180:183], v[188:203]
    v_mfma_f32_32x32x16_bf16 v[96:111], a[216:219], v[184:187], v[96:111]
gm_ck79:
    s_waitcnt vmcnt(5)
    v_max3_u32 v62, v88, v120, v124
    s_waitcnt vmcnt(4)
    v_max_u32 v62, v62, v152
    v_cmp_eq_u32 vcc, -1, v62
    s_nop 4
    s_cbranch_vccnz gm_rt81
gm_ok80:
    v_mfma_f32_32x32x16_bf16 v[188:203], a[220:223], v[184:187], v[188:203]
    v_mfma_f32_32x32x16_bf16 v[64:79], a[224:227], v[88:91], v[64:79]
    s_add_u32 s39, s91, 0
    buffer_load_dwordx4 v[172:175], v18, s[56:59], s39 offen offset:0 sc1
    v_mfma_f32_32x32x16_bf16 v[128:143], a[228:231], v[88:91], v[128:143]
    buffer_load_dwordx4 v[176:179], v18, s[56:59], s39 offen offset:1024 sc1
    v_mfma_f32_32x32x16_bf16 v[64:79], a[232:235], v[120:123], v[64:79]
    buffer_load_dwordx4 v[180:183], v18, s[56:59], s39 offen offset:2048 sc1
    v_mfma_f32_32x32x16_bf16 v[128:143], a[236:239], v[120:123], v[128:143]
    buffer_load_dwordx4 v[184:187], v18, s[56:59], s39 offen offset:3072 sc1
    v_mfma_f32_32x32x16_bf16 v[64:79], a[240:243], v[124:127], v[64:79]
    v_mfma_f32_32x32x16_bf16 v[128:143], a[244:247], v[124:127], v[128:143]
    v_mfma_f32_32x32x16_bf16 v[64:79], a[248:251], v[152:155], v[64:79]
gm_ck82:
    s_waitcnt vmcnt(5)
    v_max3_u32 v62, v156, v160, v164
    s_waitcnt vmcnt(4)
    v_max_u32 v62, v62, v168
    v_cmp_eq_u32 vcc, -1, v62
    s_nop 4
    s_cbranch_vccnz gm_rt84
gm_ok83:
    v_mfma_f32_32x32x16_bf16 v[128:143], a[252:255], v[152:155], v[128:143]
    v_mfma_f32_32x32x16_bf16 v[96:111], a[224:227], v[156:159], v[96:111]
    s_add_u32 s39, s3, 4096
    buffer_load_dwordx4 v[88:91], v18, s[56:59], s39 offen offset:0 sc1
    v_mfma_f32_32x32x16_bf16 v[188:203], a[228:231], v[156:159], v[188:203]
    buffer_load_dwordx4 v[120:123], v18, s[56:59], s39 offen offset:1024 sc1
    v_mfma_f32_32x32x16_bf16 v[96:111], a[232:235], v[160:163], v[96:111]
    buffer_load_dwordx4 v[124:127], v18, s[56:59], s39 offen offset:2048 sc1
    v_mfma_f32_32x32x16_bf16 v[188:203], a[236:239], v[160:163], v[188:203]
    buffer_load_dwordx4 v[152:155], v18, s[56:59], s39 offen offset:3072 sc1
    v_mfma_f32_32x32x16_bf16 v[96:111], a[240:243], v[164:167], v[96:111]
    v_mfma_f32_32x32x16_bf16 v[188:203], a[244:247], v[164:167], v[188:203]
    v_mfma_f32_32x32x16_bf16 v[96:111], a[248:251], v[168:171], v[96:111]
gm_ck85:
    s_waitcnt vmcnt(5)
    v_max3_u32 v62, v172, v176, v180
    s_waitcnt vmcnt(4)
    v_max_u32 v62, v62, v184
    v_cmp_eq_u32 vcc, -1, v62
    s_nop 4
    s_cbranch_vccnz gm_rt87
gm_ok86:
    v_mfma_f32_32x32x16_bf16 v[188:203], a[252:255], v[168:171], v[188:203]
    s_waitcnt lgkmcnt(15)
    v_mfma_f32_32x32x16_bf16 v[64:79], a[0:3], v[172:175], v[64:79]
    s_add_u32 s39, s91, 98304
    buffer_load_dwordx4 v[156:159], v18, s[56:59], s39 offen offset:0 sc1
    v_mfma_f32_32x32x16_bf16 v[128:143], a[4:7], v[172:175], v[128:143]
    buffer_load_dwordx4 v[160:163], v18, s[56:59], s39 offen offset:1024 sc1
    v_mfma_f32_32x32x16_bf16 v[64:79], a[8:11], v[176:179], v[64:79]
    buffer_load_dwordx4 v[164:167], v18, s[56:59], s39 offen offset:2048 sc1
    v_mfma_f32_32x32x16_bf16 v[128:143], a[12:15], v[176:179], v[128:143]
    buffer_load_dwordx4 v[168:171], v18, s[56:59], s39 offen offset:3072 sc1
    v_mfma_f32_32x32x16_bf16 v[64:79], a[16:19], v[180:183], v[64:79]
    v_mfma_f32_32x32x16_bf16 v[128:143], a[20:23], v[180:183], v[128:143]
    v_mfma_f32_32x32x16_bf16 v[64:79], a[24:27], v[184:187], v[64:79]
gm_ck88:
    s_waitcnt vmcnt(5)
    v_max3_u32 v62, v88, v120, v124
    s_waitcnt vmcnt(4)
    v_max_u32 v62, v62, v152
    v_cmp_eq_u32 vcc, -1, v62
    s_nop 4
    s_cbranch_vccnz gm_rt90
gm_ok89:
    v_mfma_f32_32x32x16_bf16 v[128:143], a[28:31], v[184:187], v[128:143]
    s_waitcnt lgkmcnt(14)
    v_mfma_f32_32x32x16_bf16 v[64:79], a[32:35], v[88:91], v[64:79]
    s_add_u32 s39, s3, 102400
    buffer_load_dwordx4 v[172:175], v18, s[56:59], s39 offen offset:0 sc1
gm_ck91:
    v_max3_u32 v62, v10, v11, v12
    v_max_u32 v62, v62, v14
    v_cmp_eq_u32 vcc, -1, v62
    s_nop 4
    s_cbranch_vccnz gm_rt93
gm_ok92:
    v_mul_f32 v20, v20, v10
    v_mul_f32 v21, v21, v10
    v_mul_f32 v22, v22, v10
    s_waitcnt lgkmcnt(12)
    v_mfma_f32_32x32x16_bf16 v[128:143], a[36:39], v[88:91], v[128:143]
    buffer_load_dwordx4 v[176:179], v18, s[56:59], s39 offen offset:1024 sc1
    v_mul_f32 v23, v23, v10
    v_mul_f32 v24, v24, v11
    v_mul_f32 v25, v25, v11
    v_mul_f32 v26, v26, v11
    s_waitcnt lgkmcnt(10)
    v_mfma_f32_32x32x16_bf16 v[64:79], a[40:43], v[120:123], v[64:79]
    buffer_load_dwordx4 v[180:183], v18, s[56:59], s39 offen offset:2048 sc1
    v_mul_f32 v27, v27, v11
    v_mul_f32 v44, v44, v12
    v_mul_f32 v45, v45, v12
    v_mul_f32 v46, v46, v12
    s_waitcnt lgkmcnt(8)
    v_mfma_f32_32x32x16_bf16 v[128:143], a[44:47], v[120:123], v[128:143]
    buffer_load_dwordx4 v[184:187], v18, s[56:59], s39 offen offset:3072 sc1
    v_mul_f32 v47, v47, v12
    v_mul_f32 v48, v48, v14
    v_mul_f32 v49, v49, v14
    v_mul_f32 v50, v50, v14
    s_waitcnt lgkmcnt(6)
    v_mfma_f32_32x32x16_bf16 v[64:79], a[48:51], v[124:127], v[64:79]
    v_mul_f32 v51, v51, v14
    s_waitcnt lgkmcnt(4)
    v_mfma_f32_32x32x16_bf16 v[128:143], a[52:55], v[124:127], v[128:143]
    s_waitcnt lgkmcnt(2)
    v_mfma_f32_32x32x16_bf16 v[64:79], a[56:59], v[152:155], v[64:79]
gm_ck94:
    s_waitcnt vmcnt(5)
    v_max3_u32 v62, v156, v160, v164
    s_waitcnt vmcnt(4)
    v_max_u32 v62, v62, v168
    v_cmp_eq_u32 vcc, -1, v62
    s_nop 4
    s_cbranch_vccnz gm_rt96
gm_ok95:
    s_waitcnt lgkmcnt(0)
    v_mfma_f32_32x32x16_bf16 v[128:143], a[60:63], v[152:155], v[128:143]
    v_mfma_f32_32x32x16_bf16 v[96:111], a[0:3], v[156:159], v[96:111]
    ds_write_b128 v15, v[64:67] offset:0
    v_mfma_f32_32x32x16_bf16 v[188:203], a[4:7], v[156:159], v[188:203]
    ds_write_b128 v16, v[68:71] offset:0
    v_mfma_f32_32x32x16_bf16 v[96:111], a[8:11], v[160:163], v[96:111]
    ds_write_b128 v19, v[72:75] offset:0
    v_mfma_f32_32x32x16_bf16 v[188:203], a[12:15], v[160:163], v[188:203]
    ds_write_b128 v29, v[76:79] offset:0
    v_mfma_f32_32x32x16_bf16 v[96:111], a[16:19], v[164:167], v[96:111]
    s_nop 2
    ds_write_b128 v15, v[128:131] offset:128
    v_mfma_f32_32x32x16_bf16 v[188:203], a[20:23], v[164:167], v[188:203]
    ds_write_b128 v16, v[132:135] offset:128
    v_mfma_f32_32x32x16_bf16 v[96:111], a[24:27], v[168:171], v[96:111]
    ds_write_b128 v19, v[136:139] offset:128
gm_ck97:
    s_waitcnt vmcnt(1)
    v_max3_u32 v62, v172, v176, v180
    s_waitcnt vmcnt(0)
    v_max_u32 v62, v62, v184
    v_cmp_eq_u32 vcc, -1, v62
    s_nop 4
    s_cbranch_vccnz gm_rt99
gm_ok98:
    v_mfma_f32_32x32x16_bf16 v[188:203], a[28:31], v[168:171], v[188:203]
    ds_write_b128 v29, v[140:143] offset:128
    v_mfma_f32_32x32x16_bf16 v[96:111], a[32:35], v[172:175], v[96:111]
    v_mfma_f32_32x32x16_bf16 v[188:203], a[36:39], v[172:175], v[188:203]
    s_waitcnt lgkmcnt(0)
    s_barrier
    ds_read_b128 v[64:67], v31 offset:0
    ds_read_b128 v[68:71], v31 offset:16384
    v_mfma_f32_32x32x16_bf16 v[96:111], a[40:43], v[176:179], v[96:111]
    ds_read_b128 v[72:75], v31 offset:32768
    ds_read_b128 v[76:79], v31 offset:49152
    v_mfma_f32_32x32x16_bf16 v[188:203], a[44:47], v[176:179], v[188:203]
    ds_read_b128 v[128:131], v34 offset:1024
    ds_read_b128 v[132:135], v34 offset:17408
    v_mfma_f32_32x32x16_bf16 v[96:111], a[48:51], v[180:183], v[96:111]
    ds_read_b128 v[136:139], v34 offset:33792
    ds_read_b128 v[140:143], v34 offset:50176
    v_mfma_f32_32x32x16_bf16 v[188:203], a[52:55], v[180:183], v[188:203]
    v_mfma_f32_32x32x16_bf16 v[96:111], a[56:59], v[184:187], v[96:111]
    v_mfma_f32_32x32x16_bf16 v[188:203], a[60:63], v[184:187], v[188:203]
    s_nop 10
    ds_write_b128 v15, v[96:99] offset:8192
    ds_write_b128 v16, v[100:103] offset:8192
    ds_write_b128 v19, v[104:107] offset:8192
    ds_write_b128 v29, v[108:111] offset:8192
    ds_write_b128 v15, v[188:191] offset:8320
    ds_write_b128 v16, v[192:195] offset:8320
    ds_write_b128 v19, v[196:199] offset:8320
    ds_write_b128 v29, v[200:203] offset:8320
    s_waitcnt lgkmcnt(14)
    v_pk_add_f32 v[64:65], v[64:65], v[68:69]
    v_pk_add_f32 v[66:67], v[66:67], v[70:71]
    s_waitcnt lgkmcnt(12)
    v_pk_add_f32 v[72:73], v[72:73], v[76:77]
    v_pk_add_f32 v[74:75], v[74:75], v[78:79]
    v_pk_add_f32 v[20:21], v[20:21], v[64:65]
    v_pk_add_f32 v[22:23], v[22:23], v[66:67]
    v_pk_add_f32 v[20:21], v[20:21], v[72:73]
    v_pk_add_f32 v[22:23], v[22:23], v[74:75]
    s_add_u32 s38, s86, 0
    buffer_store_dwordx4 v[20:23], v41, s[72:75], s38 offen sc1
    s_waitcnt lgkmcnt(10)
    v_pk_add_f32 v[128:129], v[128:129], v[132:133]
    v_pk_add_f32 v[130:131], v[130:131], v[134:135]
    s_waitcnt lgkmcnt(8)
    v_pk_add_f32 v[136:137], v[136:137], v[140:141]
    v_pk_add_f32 v[138:139], v[138:139], v[142:143]
    v_pk_add_f32 v[24:25], v[24:25], v[128:129]
    v_pk_add_f32 v[26:27], v[26:27], v[130:131]
    v_pk_add_f32 v[24:25], v[24:25], v[136:137]
    v_pk_add_f32 v[26:27], v[26:27], v[138:139]
    s_add_u32 s38, s86, 32768
    buffer_store_dwordx4 v[24:27], v41, s[72:75], s38 offen sc1
    s_waitcnt lgkmcnt(0)
    s_barrier
    ds_read_b128 v[96:99], v31 offset:8192
    ds_read_b128 v[100:103], v31 offset:24576
    ds_read_b128 v[104:107], v31 offset:40960
    ds_read_b128 v[108:111], v31 offset:57344
    ds_read_b128 v[188:191], v34 offset:9216
    ds_read_b128 v[192:195], v34 offset:25600
    ds_read_b128 v[196:199], v34 offset:41984
    ds_read_b128 v[200:203], v34 offset:58368
    s_waitcnt lgkmcnt(6)
    v_pk_add_f32 v[96:97], v[96:97], v[100:101]
    v_pk_add_f32 v[98:99], v[98:99], v[102:103]
    s_waitcnt lgkmcnt(4)
    v_pk_add_f32 v[104:105], v[104:105], v[108:109]
    v_pk_add_f32 v[106:107], v[106:107], v[110:111]
    v_pk_add_f32 v[44:45], v[44:45], v[96:97]
    v_pk_add_f32 v[46:47], v[46:47], v[98:99]
    v_pk_add_f32 v[44:45], v[44:45], v[104:105]
    v_pk_add_f32 v[46:47], v[46:47], v[106:107]
    s_add_u32 s38, s86, 65536
    buffer_store_dwordx4 v[44:47], v41, s[72:75], s38 offen sc1
    s_waitcnt lgkmcnt(2)
    v_pk_add_f32 v[188:189], v[188:189], v[192:193]
    v_pk_add_f32 v[190:191], v[190:191], v[194:195]
    s_waitcnt lgkmcnt(0)
    v_pk_add_f32 v[196:197], v[196:197], v[200:201]
    v_pk_add_f32 v[198:199], v[198:199], v[202:203]
    v_pk_add_f32 v[48:49], v[48:49], v[188:189]
    v_pk_add_f32 v[50:51], v[50:51], v[190:191]
    v_pk_add_f32 v[48:49], v[48:49], v[196:197]
    v_pk_add_f32 v[50:51], v[50:51], v[198:199]
    s_add_u32 s38, s86, 98304
    buffer_store_dwordx4 v[48:51], v41, s[72:75], s38 offen sc1
    s_add_u32 s38, s95, s94
    s_add_u32 s38, s38, s80
    s_cmp_eq_u32 s94, 0
    s_cselect_b32 s38, s38, 0
    s_cmp_eq_u32 s38, 1920
    s_cselect_b32 s38, 0, 2147418112
    buffer_store_dword v17, v61, s[56:59], s38 offen sc1
    s_endpgm
gm_rt51:
    s_add_u32 s92, s92, 1
    s_cmp_ge_u32 s92, 100000
    s_cbranch_scc1 gm_ok50
    s_mov_b32 s39, 4096
    buffer_load_dwordx4 v[208:211], v18, s[56:59], s39 offen sc1
    s_waitcnt vmcnt(0)
    s_branch gm_ck49
gm_rt54:
    s_add_u32 s92, s92, 1
    s_cmp_ge_u32 s92, 100000
    s_cbranch_scc1 gm_ok53
    buffer_load_dwordx4 v[180:183], v20, s[56:59], s25 offen sc1
    buffer_load_dwordx4 v[184:187], v21, s[56:59], s25 offen sc1
    s_waitcnt vmcnt(0)
    s_branch gm_ck52
gm_rt57:
    s_add_u32 s92, s92, 1
    s_cmp_ge_u32 s92, 100000
    s_cbranch_scc1 gm_ok56
    buffer_load_dwordx4 v[84:87], v10, s[56:59], 0 offen sc1
    buffer_load_dwordx4 v[20:23], v11, s[56:59], 0 offen offset:0 sc1
    buffer_load_dwordx4 v[24:27], v11, s[56:59], 0 offen offset:2048 sc1
    s_mov_b32 s38, 4096
    buffer_load_dwordx4 v[44:47], v11, s[56:59], s38 offen offset:0 sc1
    buffer_load_dwordx4 v[48:51], v11, s[56:59], s38 offen offset:2048 sc1
    s_mov_b32 s38, 8192
    buffer_load_dwordx4 v[64:67], v11, s[56:59], s38 offen offset:0 sc1
    buffer_load_dwordx4 v[72:75], v11, s[56:59], s38 offen offset:2048 sc1
    s_mov_b32 s38, 12288
    buffer_load_dwordx4 v[76:79], v11, s[56:59], s38 offen offset:0 sc1
    buffer_load_dwordx4 v[80:83], v11, s[56:59], s38 offen offset:2048 sc1
    s_waitcnt vmcnt(0)
    s_branch gm_ck55
gm_rt60:
    s_add_u32 s92, s92, 1
    s_cmp_ge_u32 s92, 100000
    s_cbranch_scc1 gm_ok59
    s_mov_b32 s39, 5120
    buffer_load_dwordx4 v[88:91], v18, s[56:59], s39 offen sc1
    s_waitcnt vmcnt(0)
    s_branch gm_ck58
gm_rt63:
    s_add_u32 s92, s92, 1
    s_cmp_ge_u32 s92, 100000
    s_cbranch_scc1 gm_ok62
    s_add_u32 s39, s83, 0
    buffer_load_dwordx4 v[88:91], v18, s[56:59], s39 offen offset:0 sc1
    buffer_load_dwordx4 v[120:123], v18, s[56:59], s39 offen offset:1024 sc1
    buffer_load_dwordx4 v[124:127], v18, s[56:59], s39 offen offset:2048 sc1
    buffer_load_dwordx4 v[152:155], v18, s[56:59], s39 offen offset:3072 sc1
    s_add_u32 s39, s83, 98304
    buffer_load_dwordx4 v[156:159], v18, s[56:59], s39 offen offset:0 sc1
    buffer_load_dwordx4 v[160:163], v18, s[56:59], s39 offen offset:1024 sc1
    buffer_load_dwordx4 v[164:167], v18, s[56:59], s39 offen offset:2048 sc1
    buffer_load_dwordx4 v[168:171], v18, s[56:59], s39 offen offset:3072 sc1
    s_waitcnt vmcnt(4)
    s_branch gm_ck61
gm_rt66:
    s_add_u32 s92, s92, 1
    s_cmp_ge_u32 s92, 100000
    s_cbranch_scc1 gm_ok65
    s_add_u32 s39, s83, 98304
    buffer_load_dwordx4 v[156:159], v18, s[56:59], s39 offen offset:0 sc1
    buffer_load_dwordx4 v[160:163], v18, s[56:59], s39 offen offset:1024 sc1
    buffer_load_dwordx4 v[164:167], v18, s[56:59], s39 offen offset:2048 sc1
    buffer_load_dwordx4 v[168:171], v18, s[56:59], s39 offen offset:3072 sc1
    s_add_u32 s39, s83, 4096
    buffer_load_dwordx4 v[172:175], v18, s[56:59], s39 offen offset:0 sc1
    buffer_load_dwordx4 v[176:179], v18, s[56:59], s39 offen offset:1024 sc1
    buffer_load_dwordx4 v[180:183], v18, s[56:59], s39 offen offset:2048 sc1
    buffer_load_dwordx4 v[184:187], v18, s[56:59], s39 offen offset:3072 sc1
    s_waitcnt vmcnt(4)
    s_branch gm_ck64
gm_rt69:
    s_add_u32 s92, s92, 1
    s_cmp_ge_u32 s92, 100000
    s_cbranch_scc1 gm_ok68
    s_add_u32 s39, s83, 4096
    buffer_load_dwordx4 v[172:175], v18, s[56:59], s39 offen offset:0 sc1
    buffer_load_dwordx4 v[176:179], v18, s[56:59], s39 offen offset:1024 sc1
    buffer_load_dwordx4 v[180:183], v18, s[56:59], s39 offen offset:2048 sc1
    buffer_load_dwordx4 v[184:187], v18, s[56:59], s39 offen offset:3072 sc1
    s_add_u32 s39, s83, 102400
    buffer_load_dwordx4 v[88:91], v18, s[56:59], s39 offen offset:0 sc1
    buffer_load_dwordx4 v[120:123], v18, s[56:59], s39 offen offset:1024 sc1
    buffer_load_dwordx4 v[124:127], v18, s[56:59], s39 offen offset:2048 sc1
    buffer_load_dwordx4 v[152:155], v18, s[56:59], s39 offen offset:3072 sc1
    s_waitcnt vmcnt(4)
    s_branch gm_ck67
gm_rt72:
    s_add_u32 s92, s92, 1
    s_cmp_ge_u32 s92, 100000
    s_cbranch_scc1 gm_ok71
    s_add_u32 s39, s83, 102400
    buffer_load_dwordx4 v[88:91], v18, s[56:59], s39 offen offset:0 sc1
    buffer_load_dwordx4 v[120:123], v18, s[56:59], s39 offen offset:1024 sc1
    buffer_load_dwordx4 v[124:127], v18, s[56:59], s39 offen offset:2048 sc1
    buffer_load_dwordx4 v[152:155], v18, s[56:59], s39 offen offset:3072 sc1
    s_add_u32 s39, s85, 8192
    buffer_load_dwordx4 v[156:159], v18, s[56:59], s39 offen offset:0 sc1
    buffer_load_dwordx4 v[160:163], v18, s[56:59], s39 offen offset:1024 sc1
    buffer_load_dwordx4 v[164:167], v18, s[56:59], s39 offen offset:2048 sc1
    buffer_load_dwordx4 v[168:171], v18, s[56:59], s39 offen offset:3072 sc1
    s_waitcnt vmcnt(0)
    s_branch gm_ck70
gm_rt75:
    s_add_u32 s92, s92, 1
    s_cmp_ge_u32 s92, 100000
    s_cbranch_scc1 gm_ok74
    s_add_u32 s39, s85, 8192
    buffer_load_dwordx4 v[156:159], v18, s[56:59], s39 offen offset:0 sc1
    buffer_load_dwordx4 v[160:163], v18, s[56:59], s39 offen offset:1024 sc1
    buffer_load_dwordx4 v[164:167], v18, s[56:59], s39 offen offset:2048 sc1
    buffer_load_dwordx4 v[168:171], v18, s[56:59], s39 offen offset:3072 sc1
    s_add_u32 s39, s85, 106496
    buffer_load_dwordx4 v[172:175], v18, s[56:59], s39 offen offset:0 sc1
    buffer_load_dwordx4 v[176:179], v18, s[56:59], s39 offen offset:1024 sc1
    buffer_load_dwordx4 v[180:183], v18, s[56:59], s39 offen offset:2048 sc1
    buffer_load_dwordx4 v[184:187], v18, s[56:59], s39 offen offset:3072 sc1
    s_waitcnt vmcnt(4)
    s_branch gm_ck73
gm_rt78:
    s_add_u32 s92, s92, 1
    s_cmp_ge_u32 s92, 100000
    s_cbranch_scc1 gm_ok77
    s_add_u32 s39, s85, 106496
    buffer_load_dwordx4 v[172:175], v18, s[56:59], s39 offen offset:0 sc1
    buffer_load_dwordx4 v[176:179], v18, s[56:59], s39 offen offset:1024 sc1
    buffer_load_dwordx4 v[180:183], v18, s[56:59], s39 offen offset:2048 sc1
    buffer_load_dwordx4 v[184:187], v18, s[56:59], s39 offen offset:3072 sc1
    s_add_u32 s39, s85, 12288
    buffer_load_dwordx4 v[88:91], v18, s[56:59], s39 offen offset:0 sc1
    buffer_load_dwordx4 v[120:123], v18, s[56:59], s39 offen offset:1024 sc1
    buffer_load_dwordx4 v[124:127], v18, s[56:59], s39 offen offset:2048 sc1
    buffer_load_dwordx4 v[152:155], v18, s[56:59], s39 offen offset:3072 sc1
    s_waitcnt vmcnt(4)
    s_branch gm_ck76
gm_rt81:
    s_add_u32 s92, s92, 1
    s_cmp_ge_u32 s92, 100000
    s_cbranch_scc1 gm_ok80
    s_add_u32 s39, s85, 12288
    buffer_load_dwordx4 v[88:91], v18, s[56:59], s39 offen offset:0 sc1
    buffer_load_dwordx4 v[120:123], v18, s[56:59], s39 offen offset:1024 sc1
    buffer_load_dwordx4 v[124:127], v18, s[56:59], s39 offen offset:2048 sc1
    buffer_load_dwordx4 v[152:155], v18, s[56:59], s39 offen offset:3072 sc1
    s_add_u32 s39, s85, 110592
    buffer_load_dwordx4 v[156:159], v18, s[56:59], s39 offen offset:0 sc1
    buffer_load_dwordx4 v[160:163], v18, s[56:59], s39 offen offset:1024 sc1
    buffer_load_dwordx4 v[164:167], v18, s[56:59], s39 offen offset:2048 sc1
    buffer_load_dwordx4 v[168:171], v18, s[56:59], s39 offen offset:3072 sc1
    s_waitcnt vmcnt(4)
    s_branch gm_ck79
gm_rt84:
    s_add_u32 s92, s92, 1
    s_cmp_ge_u32 s92, 100000
    s_cbranch_scc1 gm_ok83
    s_add_u32 s39, s85, 110592
    buffer_load_dwordx4 v[156:159], v18, s[56:59], s39 offen offset:0 sc1
    buffer_load_dwordx4 v[160:163], v18, s[56:59], s39 offen offset:1024 sc1
    buffer_load_dwordx4 v[164:167], v18, s[56:59], s39 offen offset:2048 sc1
    buffer_load_dwordx4 v[168:171], v18, s[56:59], s39 offen offset:3072 sc1
    s_add_u32 s39, s91, 0
    buffer_load_dwordx4 v[172:175], v18, s[56:59], s39 offen offset:0 sc1
    buffer_load_dwordx4 v[176:179], v18, s[56:59], s39 offen offset:1024 sc1
    buffer_load_dwordx4 v[180:183], v18, s[56:59], s39 offen offset:2048 sc1
    buffer_load_dwordx4 v[184:187], v18, s[56:59], s39 offen offset:3072 sc1
    s_waitcnt vmcnt(4)
    s_branch gm_ck82
gm_rt87:
    s_add_u32 s92, s92, 1
    s_cmp_ge_u32 s92, 100000
    s_cbranch_scc1 gm_ok86
    s_add_u32 s39, s91, 0
    buffer_load_dwordx4 v[172:175], v18, s[56:59], s39 offen offset:0 sc1
    buffer_load_dwordx4 v[176:179], v18, s[56:59], s39 offen offset:1024 sc1
    buffer_load_dwordx4 v[180:183], v18, s[56:59], s39 offen offset:2048 sc1
    buffer_load_dwordx4 v[184:187], v18, s[56:59], s39 offen offset:3072 sc1
    s_add_u32 s39, s3, 4096
    buffer_load_dwordx4 v[88:91], v18, s[56:59], s39 offen offset:0 sc1
    buffer_load_dwordx4 v[120:123], v18, s[56:59], s39 offen offset:1024 sc1
    buffer_load_dwordx4 v[124:127], v18, s[56:59], s39 offen offset:2048 sc1
    buffer_load_dwordx4 v[152:155], v18, s[56:59], s39 offen offset:3072 sc1
    s_waitcnt vmcnt(4)
    s_branch gm_ck85
gm_rt90:
    s_add_u32 s92, s92, 1
    s_cmp_ge_u32 s92, 100000
    s_cbranch_scc1 gm_ok89
    s_add_u32 s39, s3, 4096
    buffer_load_dwordx4 v[88:91], v18, s[56:59], s39 offen offset:0 sc1
    buffer_load_dwordx4 v[120:123], v18, s[56:59], s39 offen offset:1024 sc1
    buffer_load_dwordx4 v[124:127], v18, s[56:59], s39 offen offset:2048 sc1
    buffer_load_dwordx4 v[152:155], v18, s[56:59], s39 offen offset:3072 sc1
    s_add_u32 s39, s91, 98304
    buffer_load_dwordx4 v[156:159], v18, s[56:59], s39 offen offset:0 sc1
    buffer_load_dwordx4 v[160:163], v18, s[56:59], s39 offen offset:1024 sc1
    buffer_load_dwordx4 v[164:167], v18, s[56:59], s39 offen offset:2048 sc1
    buffer_load_dwordx4 v[168:171], v18, s[56:59], s39 offen offset:3072 sc1
    s_waitcnt vmcnt(4)
    s_branch gm_ck88
gm_rt93:
    s_add_u32 s92, s92, 1
    s_cmp_ge_u32 s92, 100000
    s_cbranch_scc1 gm_ok92
    s_lshr_b32 s88, s95, 6
    s_lshl_b32 s88, s88, 8
    s_lshl_b32 s89, s80, 5
    s_add_u32 s88, s88, s89
    s_add_u32 s88, s88, 720896
    buffer_load_dword v10, v9, s[56:59], s88 offen offset:0 sc1
    buffer_load_dword v11, v9, s[56:59], s88 offen offset:16 sc1
    buffer_load_dword v12, v9, s[56:59], s88 offen offset:128 sc1
    buffer_load_dword v14, v9, s[56:59], s88 offen offset:144 sc1
    s_waitcnt vmcnt(0)
    s_branch gm_ck91
gm_rt96:
    s_add_u32 s92, s92, 1
    s_cmp_ge_u32 s92, 100000
    s_cbranch_scc1 gm_ok95
    s_add_u32 s39, s91, 98304
    buffer_load_dwordx4 v[156:159], v18, s[56:59], s39 offen offset:0 sc1
    buffer_load_dwordx4 v[160:163], v18, s[56:59], s39 offen offset:1024 sc1
    buffer_load_dwordx4 v[164:167], v18, s[56:59], s39 offen offset:2048 sc1
    buffer_load_dwordx4 v[168:171], v18, s[56:59], s39 offen offset:3072 sc1
    s_add_u32 s39, s3, 102400
    buffer_load_dwordx4 v[172:175], v18, s[56:59], s39 offen offset:0 sc1
    buffer_load_dwordx4 v[176:179], v18, s[56:59], s39 offen offset:1024 sc1
    buffer_load_dwordx4 v[180:183], v18, s[56:59], s39 offen offset:2048 sc1
    buffer_load_dwordx4 v[184:187], v18, s[56:59], s39 offen offset:3072 sc1
    s_waitcnt vmcnt(4)
    s_branch gm_ck94
gm_rt99:
    s_add_u32 s92, s92, 1
    s_cmp_ge_u32 s92, 100000
    s_cbranch_scc1 gm_ok98
    s_add_u32 s39, s3, 102400
    buffer_load_dwordx4 v[172:175], v18, s[56:59], s39 offen offset:0 sc1
    buffer_load_dwordx4 v[176:179], v18, s[56:59], s39 offen offset:1024 sc1
    buffer_load_dwordx4 v[180:183], v18, s[56:59], s39 offen offset:2048 sc1
    buffer_load_dwordx4 v[184:187], v18, s[56:59], s39 offen offset:3072 sc1
    s_waitcnt vmcnt(0)
    s_branch gm_ck97
gm_END:
    s_endpgm
.section .rodata,"a"
.p2align 6
.amdhsa_kernel gated_mix__linear_kernel_hedgehog__ssm_conv_s5__prompt_kernel
  .amdhsa_next_free_vgpr 512
  .amdhsa_next_free_sgpr 102
  .amdhsa_accum_offset 256
  .amdhsa_group_segment_fixed_size 0
  .amdhsa_kernarg_size 136
  .amdhsa_user_sgpr_count 2
  .amdhsa_user_sgpr_kernarg_segment_ptr 1
  .amdhsa_system_sgpr_workgroup_id_x 1
.end_amdhsa_kernel
```
